```python
import torch

def _softmax(x, axis=-1):
    return torch.softmax(x, dim=axis)
def _gelu(x):
    return torch.nn.functional.gelu(x, approximate="tanh")
def _silu(x):
    return torch.nn.functional.silu(x)
def _sigmoid(x):
    return torch.sigmoid(x)
def _layernorm(x, axis=-1, eps=1e-5):
    m = x.mean(dim=axis, keepdim=True)
    v = x.var(dim=axis, keepdim=True, unbiased=False)
    return (x - m) / torch.sqrt(v + eps)
def _scatter_add(tgt, idx, src, axis=0):
    return tgt.clone().index_add_(axis, idx, src)
def _segment_sum(src, seg, n):
    out = torch.zeros((n,) + src.shape[1:], dtype=src.dtype)
    return out.index_add_(0, seg, src)
def _pad(x, pw):
    flat = tuple(v for pair in reversed(pw) for v in pair)
    return torch.nn.functional.pad(x, flat)

kernel_name = 'gated_mix__linear_attn_block__ssm_conv_h3__prompt'

def setup_inputs():

    _w = (lambda a: (lambda t: t.to(torch.bfloat16) if t.is_floating_point() else t)(torch.as_tensor(a)))
    def _A_setup():
        B, S, D = 1, 2048, 1024
        return {
            "x": _w((lambda *s: torch.randn(*s, dtype=torch.bfloat16) * 0.05)(B, S, D)),
            "wqkv": _w((lambda *s: torch.randn(*s, dtype=torch.bfloat16) * 1.6)(D, 3 * D)),
            "wo": _w((lambda *s: torch.randn(*s, dtype=torch.bfloat16) * 0.05)(D, D)),
        }
    _A_in = _A_setup()

    def _B_setup():
        B, S, D = 1, 2048, 1024
        ks = 4
        return {
            "q": _w((lambda *s: torch.randn(*s, dtype=torch.bfloat16) * 0.05)(B, S, D)),
            "k": _w((lambda *s: torch.randn(*s, dtype=torch.bfloat16) * 0.8)(B, S, D)),
            "v": _w((lambda *s: torch.randn(*s, dtype=torch.bfloat16) * 0.4)(B, S, D)),
            "shift_k": _w((lambda *s: torch.randn(*s, dtype=torch.bfloat16) * 0.8)(D, ks) * 0.5),
            "ssm_k": _w((lambda *s: torch.randn(*s, dtype=torch.bfloat16) * 1.6)(D, S) * (1.0 / S ** 0.5)),
            "ssm_D": _w((lambda *s: torch.randn(*s, dtype=torch.bfloat16) * 0.4)(D)),
        }
    _B_in = _B_setup()

    return {
        "A_x": _A_in["x"],
        "A_wqkv": _A_in["wqkv"],
        "A_wo": _A_in["wo"],
        "B_q": _B_in["q"],
        "B_k": _B_in["k"],
        "B_v": _B_in["v"],
        "B_shift_k": _B_in["shift_k"],
        "B_ssm_k": _B_in["ssm_k"],
        "B_ssm_D": _B_in["ssm_D"],
        "gate_w": _w((lambda *s: torch.randn(*s, dtype=torch.bfloat16) * 0.05)(1024) * 16.0),
    }

def reference(A_x, A_wqkv, A_wo, B_q, B_k, B_v, B_shift_k, B_ssm_k, B_ssm_D, gate_w):
    def _A_ref(x, wqkv, wo):
        B, S, D = x.shape
        H = 32; Dh = D // H
        qkv = (lambda x, *d: x.permute(*d))((x @ wqkv).reshape(B, S, 3, H, Dh), 2, 0, 3, 1, 4)
        q, k, v = qkv[0], qkv[1], qkv[2]
        phi = lambda t: torch.where(t > 0, t + 1, torch.exp(t)) + 1e-6
        pq, pk = phi(q), phi(k)
        kv = torch.einsum("bhsd,bhse->bhde", pk, v)
        z = torch.einsum("bhsd->bhd", pk)
        num = torch.einsum("bhqd,bhde->bhqe", pq, kv)
        den = torch.einsum("bhqd,bhd->bhq", pq, z)[..., None] + 1e-6
        o = num / den
        return (lambda x, *d: x.permute(*d))(o, 0, 2, 1, 3).reshape(B, S, D) @ wo

    def _B_ref(q, k, v, shift_k, ssm_k, ssm_D):
        B, S, D = q.shape
        ks = shift_k.shape[-1]
        k_pad = _pad(k, ((0, 0), (ks - 1, 0), (0, 0)))
        k_shift = torch.zeros_like(k)
        for t in range(ks):
            k_shift = k_shift + k_pad[:, t:t + S, :] * shift_k[:, ks - 1 - t][None, None, :]
        kv = k_shift * v
        L = 2 * S
        kv_pad = _pad(kv, ((0, 0), (0, S), (0, 0)))
        kf_pad = _pad(ssm_k, ((0, 0), (0, S)))
        kv_f = (lambda x, axes=(-2,-1): torch.fft.rfft2(x.float(), dim=axes))(kv_pad[:, None, :, :], axes=(1, 2))
        kf_f = (lambda x, axes=(-2,-1): torch.fft.rfft2(x.float(), dim=axes))(kf_pad[:, None, :], axes=(1, 2))
        kf_f = (lambda x, *d: x.permute(*d))(kf_f, 1, 2, 0)
        y_f = kv_f * kf_f[None, :, :, :]
        y = (lambda x, s, axes=(-2,-1): torch.fft.irfft2(x, s=s, dim=axes).to(torch.bfloat16))(y_f, (1, L), axes=(1, 2))[:, 0, :S, :]
        y = y + kv * ssm_D[None, None, :]
        return q * y

    x = A_x
    g = _sigmoid((x * gate_w).sum(-1, keepdims=True))
    a = _A_ref(x, A_wqkv, A_wo)
    b = _B_ref(x, B_k, B_v, B_shift_k, B_ssm_k, B_ssm_D)
    return g * a + (1 - g) * b
```

```asm
; @launch grid=(256,1,1) block=(512,1,1) lds=163840
.amdgcn_target "amdgcn-amd-amdhsa--gfx950"
.text
.globl gated_mix__linear_attn_block__ssm_conv_h3__prompt_kernel
.p2align 8
.type gated_mix__linear_attn_block__ssm_conv_h3__prompt_kernel,@function
gated_mix__linear_attn_block__ssm_conv_h3__prompt_kernel:
s_cmp_ge_u32 s2, 256
s_cbranch_scc1 Ldone
s_load_dwordx4 s[4:7], s[0:1], 0
s_load_dwordx4 s[12:15], s[0:1], 88
v_lshrrev_b32 v1, 6, v0
v_and_b32 v0, 63, v0
v_readfirstlane_b32 s50, v1
s_and_b32 s51, s2, 7
s_lshr_b32 s52, s2, 3
s_lshl_b32 s53, s51, 3
s_and_b32 s53, s53, 8
s_and_b32 s54, s52, 7
s_or_b32 s48, s53, s54
s_lshl_b32 s53, s51, 1
s_and_b32 s53, s53, 12
s_lshr_b32 s54, s52, 3
s_or_b32 s49, s53, s54
s_lshr_b32 s53, s49, 2
s_add_u32 s53, s53, 1
s_and_b32 s53, s53, 2
s_mul_i32 s53, s53, 6
s_xor_b32 s49, s49, s53
s_and_b32 s53, s51, 3
s_lshl_b32 s53, s53, 2
s_and_b32 s54, s52, 3
s_or_b32 s96, s53, s54
s_lshr_b32 s53, s51, 2
s_lshl_b32 s53, s53, 3
s_lshr_b32 s54, s52, 2
s_or_b32 s97, s53, s54
s_cmp_ge_u32 s50, 4
s_cbranch_scc1 Laux
s_setprio 2
s_and_b32 s53, s50, 1
s_lshr_b32 s54, s50, 1
v_and_b32 v2, 15, v0
v_lshrrev_b32 v3, 4, v0
v_lshrrev_b32 v4, 1, v2
v_xor_b32 v4, v4, v3
s_lshl_b32 s55, s53, 13
v_lshlrev_b32 v5, 7, v2
v_add_u32 v5, s55, v5
v_lshl_add_u32 v8, v4, 4, v5
v_xor_b32 v6, 4, v4
v_lshl_add_u32 v9, v6, 4, v5
v_add_u32 v10, 81920, v8
v_add_u32 v11, 81920, v9
v_bfe_u32 v6, v0, 2, 2
v_lshl_add_u32 v7, v3, 3, v6
v_lshlrev_b32 v7, 7, v7
v_and_b32 v18, 3, v0
v_lshl_add_u32 v7, v18, 3, v7
v_add_u32 v7, 16384, v7
v_bfe_u32 v18, v0, 3, 1
v_bfe_u32 v19, v0, 4, 1
v_lshl_or_b32 v18, v19, 1, v18
s_lshl_b32 s55, s54, 1
v_xor_b32 v18, s55, v18
v_lshl_add_u32 v12, v18, 5, v7
v_xor_b32 v18, 1, v18
v_lshl_add_u32 v13, v18, 5, v7
v_add_u32 v14, 81920, v12
v_add_u32 v15, 81920, v13
v_mov_b32 v64, 0
v_mov_b32 v65, 0
v_mov_b32 v66, 0
v_mov_b32 v67, 0
v_mov_b32 v68, 0
v_mov_b32 v69, 0
v_mov_b32 v70, 0
v_mov_b32 v71, 0
v_mov_b32 v72, 0
v_mov_b32 v73, 0
v_mov_b32 v74, 0
v_mov_b32 v75, 0
v_mov_b32 v76, 0
v_mov_b32 v77, 0
v_mov_b32 v78, 0
v_mov_b32 v79, 0
v_mov_b32 v80, 0
v_mov_b32 v81, 0
v_mov_b32 v82, 0
v_mov_b32 v83, 0
v_mov_b32 v84, 0
v_mov_b32 v85, 0
v_mov_b32 v86, 0
v_mov_b32 v87, 0
v_mov_b32 v88, 0
v_mov_b32 v89, 0
v_mov_b32 v90, 0
v_mov_b32 v91, 0
v_mov_b32 v92, 0
v_mov_b32 v93, 0
v_mov_b32 v94, 0
v_mov_b32 v95, 0
v_mov_b32 v96, 0
v_mov_b32 v97, 0
v_mov_b32 v98, 0
v_mov_b32 v99, 0
v_mov_b32 v100, 0
v_mov_b32 v101, 0
v_mov_b32 v102, 0
v_mov_b32 v103, 0
v_mov_b32 v104, 0
v_mov_b32 v105, 0
v_mov_b32 v106, 0
v_mov_b32 v107, 0
v_mov_b32 v108, 0
v_mov_b32 v109, 0
v_mov_b32 v110, 0
v_mov_b32 v111, 0
v_mov_b32 v112, 0
v_mov_b32 v113, 0
v_mov_b32 v114, 0
v_mov_b32 v115, 0
v_mov_b32 v116, 0
v_mov_b32 v117, 0
v_mov_b32 v118, 0
v_mov_b32 v119, 0
v_mov_b32 v120, 0
v_mov_b32 v121, 0
v_mov_b32 v122, 0
v_mov_b32 v123, 0
v_mov_b32 v124, 0
v_mov_b32 v125, 0
v_mov_b32 v126, 0
v_mov_b32 v127, 0
v_mov_b32 v128, 0
v_mov_b32 v129, 0
v_mov_b32 v130, 0
v_mov_b32 v131, 0
v_mov_b32 v132, 0
v_mov_b32 v133, 0
v_mov_b32 v134, 0
v_mov_b32 v135, 0
v_mov_b32 v136, 0
v_mov_b32 v137, 0
v_mov_b32 v138, 0
v_mov_b32 v139, 0
v_mov_b32 v140, 0
v_mov_b32 v141, 0
v_mov_b32 v142, 0
v_mov_b32 v143, 0
v_mov_b32 v144, 0
v_mov_b32 v145, 0
v_mov_b32 v146, 0
v_mov_b32 v147, 0
v_mov_b32 v148, 0
v_mov_b32 v149, 0
v_mov_b32 v150, 0
v_mov_b32 v151, 0
v_mov_b32 v152, 0
v_mov_b32 v153, 0
v_mov_b32 v154, 0
v_mov_b32 v155, 0
v_mov_b32 v156, 0
v_mov_b32 v157, 0
v_mov_b32 v158, 0
v_mov_b32 v159, 0
s_mov_b32 s56, 0x3fb8aa3b
s_mov_b32 s57, 0x3fb8aa3b
s_mov_b32 s58, 0x358637bd
s_mov_b32 s59, 0x358637bd
s_waitcnt lgkmcnt(0)
s_mov_b32 s36, s14
s_mov_b32 s37, s15
s_mov_b32 s38, 20971520
s_mov_b32 s39, 0x00020000
s_mov_b32 s40, s12
s_mov_b32 s41, s13
s_mov_b32 s42, 256
s_mov_b32 s43, 0x00020000
s_load_dwordx2 s[18:19], s[0:1], 16
s_cmp_eq_u32 s50, 0
s_cbranch_scc0 Lnz
s_lshl_b32 s55, s49, 4
s_add_u32 s55, s55, s48
s_lshl_b32 s55, s55, 7
s_add_u32 s55, s55, 12058624
v_writelane_b32 v18, s55, 0
s_lshl_b32 s55, s2, 7
s_add_u32 s55, s55, 12091392
v_writelane_b32 v18, s55, 1
s_lshl_b32 s55, s48, 4
s_add_u32 s55, s55, s49
s_lshl_b32 s55, s55, 7
s_add_u32 s55, s55, 12124160
v_writelane_b32 v18, s55, 2
s_lshl_b32 s55, s51, 5
s_add_u32 s55, s55, s52
s_lshl_b32 s55, s55, 7
s_add_u32 s55, s55, 12156928
v_writelane_b32 v18, s55, 3
v_mov_b32 v19, 0
v_mov_b32 v20, 1
s_mov_b64 exec, 15
buffer_store_dword v19, v18, s[36:39], 0 offen sc1
s_mov_b64 exec, -1
Lnz:
s_barrier
ds_read_b128 v[160:163], v8 offset:0
ds_read_b64_tr_b16 v[176:177], v12 offset:0
ds_read_b64_tr_b16 v[178:179], v12 offset:512
ds_read_b128 v[164:167], v8 offset:2048
ds_read_b128 v[168:171], v8 offset:4096
ds_read_b128 v[172:175], v8 offset:6144
ds_read_b64_tr_b16 v[180:181], v13 offset:0
ds_read_b64_tr_b16 v[182:183], v13 offset:512
ds_read_b64_tr_b16 v[184:185], v12 offset:8192
ds_read_b64_tr_b16 v[186:187], v12 offset:8704
ds_read_b64_tr_b16 v[188:189], v13 offset:8192
ds_read_b64_tr_b16 v[190:191], v13 offset:8704
ds_read_b64_tr_b16 v[192:193], v12 offset:16384
ds_read_b64_tr_b16 v[194:195], v12 offset:16896
ds_read_b64_tr_b16 v[196:197], v13 offset:16384
ds_read_b64_tr_b16 v[198:199], v13 offset:16896
s_mov_b32 s60, 0
.p2align 6
Lcloop:
s_waitcnt lgkmcnt(0)
s_cmp_eq_u32 s60, 2
s_cselect_b32 s61, s50, 1
s_cmp_eq_u32 s61, 0
s_cbranch_scc0 Lnat
s_waitcnt vmcnt(0)
s_mov_b64 exec, 1
buffer_atomic_add v20, v19, s[40:43], 0 offen sc1
s_mov_b64 exec, -1
s_nop 4
Lnat:
v_mfma_f32_16x16x32_bf16 v[64:67], v[176:179], v[160:163], v[64:67]
ds_read_b128 v[200:203], v9 offset:0
v_mfma_f32_16x16x32_bf16 v[68:71], v[176:179], v[164:167], v[68:71]
ds_read_b64_tr_b16 v[216:217], v12 offset:4096
v_mfma_f32_16x16x32_bf16 v[72:75], v[176:179], v[168:171], v[72:75]
ds_read_b64_tr_b16 v[218:219], v12 offset:4608
v_mfma_f32_16x16x32_bf16 v[76:79], v[176:179], v[172:175], v[76:79]
ds_read_b128 v[204:207], v9 offset:2048
v_mfma_f32_16x16x32_bf16 v[80:83], v[180:183], v[160:163], v[80:83]
ds_read_b128 v[208:211], v9 offset:4096
v_mfma_f32_16x16x32_bf16 v[84:87], v[180:183], v[164:167], v[84:87]
ds_read_b128 v[212:215], v9 offset:6144
v_mfma_f32_16x16x32_bf16 v[88:91], v[180:183], v[168:171], v[88:91]
ds_read_b64_tr_b16 v[220:221], v13 offset:4096
v_mfma_f32_16x16x32_bf16 v[92:95], v[180:183], v[172:175], v[92:95]
ds_read_b64_tr_b16 v[222:223], v13 offset:4608
v_mfma_f32_16x16x32_bf16 v[96:99], v[160:163], v[184:187], v[96:99]
ds_read_b64_tr_b16 v[224:225], v12 offset:12288
v_mfma_f32_16x16x32_bf16 v[100:103], v[164:167], v[184:187], v[100:103]
ds_read_b64_tr_b16 v[226:227], v12 offset:12800
v_mfma_f32_16x16x32_bf16 v[104:107], v[168:171], v[184:187], v[104:107]
ds_read_b64_tr_b16 v[228:229], v13 offset:12288
v_mfma_f32_16x16x32_bf16 v[108:111], v[172:175], v[184:187], v[108:111]
ds_read_b64_tr_b16 v[230:231], v13 offset:12800
v_mfma_f32_16x16x32_bf16 v[112:115], v[160:163], v[188:191], v[112:115]
ds_read_b64_tr_b16 v[232:233], v12 offset:20480
v_mfma_f32_16x16x32_bf16 v[116:119], v[164:167], v[188:191], v[116:119]
ds_read_b64_tr_b16 v[234:235], v12 offset:20992
v_mfma_f32_16x16x32_bf16 v[120:123], v[168:171], v[188:191], v[120:123]
ds_read_b64_tr_b16 v[236:237], v13 offset:20480
v_mfma_f32_16x16x32_bf16 v[124:127], v[172:175], v[188:191], v[124:127]
ds_read_b64_tr_b16 v[238:239], v13 offset:20992
v_mfma_f32_16x16x32_bf16 v[128:131], v[160:163], v[192:195], v[128:131]
v_mfma_f32_16x16x32_bf16 v[132:135], v[164:167], v[192:195], v[132:135]
v_mfma_f32_16x16x32_bf16 v[136:139], v[168:171], v[192:195], v[136:139]
v_mfma_f32_16x16x32_bf16 v[140:143], v[172:175], v[192:195], v[140:143]
v_mfma_f32_16x16x32_bf16 v[144:147], v[160:163], v[196:199], v[144:147]
v_mfma_f32_16x16x32_bf16 v[148:151], v[164:167], v[196:199], v[148:151]
v_mfma_f32_16x16x32_bf16 v[152:155], v[168:171], v[196:199], v[152:155]
v_mfma_f32_16x16x32_bf16 v[156:159], v[172:175], v[196:199], v[156:159]
s_waitcnt lgkmcnt(0)
v_mfma_f32_16x16x32_bf16 v[64:67], v[216:219], v[200:203], v[64:67]
v_mfma_f32_16x16x32_bf16 v[68:71], v[216:219], v[204:207], v[68:71]
v_mfma_f32_16x16x32_bf16 v[72:75], v[216:219], v[208:211], v[72:75]
v_mfma_f32_16x16x32_bf16 v[76:79], v[216:219], v[212:215], v[76:79]
s_barrier
ds_read_b128 v[160:163], v8 offset:40960
v_mfma_f32_16x16x32_bf16 v[80:83], v[220:223], v[200:203], v[80:83]
ds_read_b64_tr_b16 v[176:177], v12 offset:40960
v_mfma_f32_16x16x32_bf16 v[84:87], v[220:223], v[204:207], v[84:87]
ds_read_b64_tr_b16 v[178:179], v12 offset:41472
v_mfma_f32_16x16x32_bf16 v[88:91], v[220:223], v[208:211], v[88:91]
ds_read_b128 v[164:167], v8 offset:43008
v_mfma_f32_16x16x32_bf16 v[92:95], v[220:223], v[212:215], v[92:95]
ds_read_b128 v[168:171], v8 offset:45056
v_mfma_f32_16x16x32_bf16 v[96:99], v[200:203], v[224:227], v[96:99]
ds_read_b128 v[172:175], v8 offset:47104
v_mfma_f32_16x16x32_bf16 v[100:103], v[204:207], v[224:227], v[100:103]
ds_read_b64_tr_b16 v[180:181], v13 offset:40960
v_mfma_f32_16x16x32_bf16 v[104:107], v[208:211], v[224:227], v[104:107]
ds_read_b64_tr_b16 v[182:183], v13 offset:41472
v_mfma_f32_16x16x32_bf16 v[108:111], v[212:215], v[224:227], v[108:111]
ds_read_b64_tr_b16 v[184:185], v12 offset:49152
v_mfma_f32_16x16x32_bf16 v[112:115], v[200:203], v[228:231], v[112:115]
ds_read_b64_tr_b16 v[186:187], v12 offset:49664
v_mfma_f32_16x16x32_bf16 v[116:119], v[204:207], v[228:231], v[116:119]
ds_read_b64_tr_b16 v[188:189], v13 offset:49152
v_mfma_f32_16x16x32_bf16 v[120:123], v[208:211], v[228:231], v[120:123]
ds_read_b64_tr_b16 v[190:191], v13 offset:49664
v_mfma_f32_16x16x32_bf16 v[124:127], v[212:215], v[228:231], v[124:127]
ds_read_b64_tr_b16 v[192:193], v12 offset:57344
v_mfma_f32_16x16x32_bf16 v[128:131], v[200:203], v[232:235], v[128:131]
ds_read_b64_tr_b16 v[194:195], v12 offset:57856
v_mfma_f32_16x16x32_bf16 v[132:135], v[204:207], v[232:235], v[132:135]
ds_read_b64_tr_b16 v[196:197], v13 offset:57344
v_mfma_f32_16x16x32_bf16 v[136:139], v[208:211], v[232:235], v[136:139]
ds_read_b64_tr_b16 v[198:199], v13 offset:57856
v_mfma_f32_16x16x32_bf16 v[140:143], v[212:215], v[232:235], v[140:143]
v_mfma_f32_16x16x32_bf16 v[144:147], v[200:203], v[236:239], v[144:147]
v_mfma_f32_16x16x32_bf16 v[148:151], v[204:207], v[236:239], v[148:151]
v_mfma_f32_16x16x32_bf16 v[152:155], v[208:211], v[236:239], v[152:155]
v_mfma_f32_16x16x32_bf16 v[156:159], v[212:215], v[236:239], v[156:159]
s_waitcnt lgkmcnt(0)
v_mfma_f32_16x16x32_bf16 v[64:67], v[176:179], v[160:163], v[64:67]
ds_read_b128 v[200:203], v9 offset:40960
v_mfma_f32_16x16x32_bf16 v[68:71], v[176:179], v[164:167], v[68:71]
ds_read_b64_tr_b16 v[216:217], v12 offset:45056
v_mfma_f32_16x16x32_bf16 v[72:75], v[176:179], v[168:171], v[72:75]
ds_read_b64_tr_b16 v[218:219], v12 offset:45568
v_mfma_f32_16x16x32_bf16 v[76:79], v[176:179], v[172:175], v[76:79]
ds_read_b128 v[204:207], v9 offset:43008
v_mfma_f32_16x16x32_bf16 v[80:83], v[180:183], v[160:163], v[80:83]
ds_read_b128 v[208:211], v9 offset:45056
v_mfma_f32_16x16x32_bf16 v[84:87], v[180:183], v[164:167], v[84:87]
ds_read_b128 v[212:215], v9 offset:47104
v_mfma_f32_16x16x32_bf16 v[88:91], v[180:183], v[168:171], v[88:91]
ds_read_b64_tr_b16 v[220:221], v13 offset:45056
v_mfma_f32_16x16x32_bf16 v[92:95], v[180:183], v[172:175], v[92:95]
ds_read_b64_tr_b16 v[222:223], v13 offset:45568
v_mfma_f32_16x16x32_bf16 v[96:99], v[160:163], v[184:187], v[96:99]
ds_read_b64_tr_b16 v[224:225], v12 offset:53248
v_mfma_f32_16x16x32_bf16 v[100:103], v[164:167], v[184:187], v[100:103]
ds_read_b64_tr_b16 v[226:227], v12 offset:53760
v_mfma_f32_16x16x32_bf16 v[104:107], v[168:171], v[184:187], v[104:107]
ds_read_b64_tr_b16 v[228:229], v13 offset:53248
v_mfma_f32_16x16x32_bf16 v[108:111], v[172:175], v[184:187], v[108:111]
ds_read_b64_tr_b16 v[230:231], v13 offset:53760
v_mfma_f32_16x16x32_bf16 v[112:115], v[160:163], v[188:191], v[112:115]
ds_read_b64_tr_b16 v[232:233], v12 offset:61440
v_mfma_f32_16x16x32_bf16 v[116:119], v[164:167], v[188:191], v[116:119]
ds_read_b64_tr_b16 v[234:235], v12 offset:61952
v_mfma_f32_16x16x32_bf16 v[120:123], v[168:171], v[188:191], v[120:123]
ds_read_b64_tr_b16 v[236:237], v13 offset:61440
v_mfma_f32_16x16x32_bf16 v[124:127], v[172:175], v[188:191], v[124:127]
ds_read_b64_tr_b16 v[238:239], v13 offset:61952
v_mfma_f32_16x16x32_bf16 v[128:131], v[160:163], v[192:195], v[128:131]
v_mfma_f32_16x16x32_bf16 v[132:135], v[164:167], v[192:195], v[132:135]
v_mfma_f32_16x16x32_bf16 v[136:139], v[168:171], v[192:195], v[136:139]
v_mfma_f32_16x16x32_bf16 v[140:143], v[172:175], v[192:195], v[140:143]
v_mfma_f32_16x16x32_bf16 v[144:147], v[160:163], v[196:199], v[144:147]
v_mfma_f32_16x16x32_bf16 v[148:151], v[164:167], v[196:199], v[148:151]
v_mfma_f32_16x16x32_bf16 v[152:155], v[168:171], v[196:199], v[152:155]
v_mfma_f32_16x16x32_bf16 v[156:159], v[172:175], v[196:199], v[156:159]
s_waitcnt lgkmcnt(0)
v_mfma_f32_16x16x32_bf16 v[64:67], v[216:219], v[200:203], v[64:67]
v_mfma_f32_16x16x32_bf16 v[68:71], v[216:219], v[204:207], v[68:71]
v_mfma_f32_16x16x32_bf16 v[72:75], v[216:219], v[208:211], v[72:75]
v_mfma_f32_16x16x32_bf16 v[76:79], v[216:219], v[212:215], v[76:79]
s_barrier
ds_read_b128 v[160:163], v10 offset:0
v_mfma_f32_16x16x32_bf16 v[80:83], v[220:223], v[200:203], v[80:83]
ds_read_b64_tr_b16 v[176:177], v14 offset:0
v_mfma_f32_16x16x32_bf16 v[84:87], v[220:223], v[204:207], v[84:87]
ds_read_b64_tr_b16 v[178:179], v14 offset:512
v_mfma_f32_16x16x32_bf16 v[88:91], v[220:223], v[208:211], v[88:91]
ds_read_b128 v[164:167], v10 offset:2048
v_mfma_f32_16x16x32_bf16 v[92:95], v[220:223], v[212:215], v[92:95]
ds_read_b128 v[168:171], v10 offset:4096
v_mfma_f32_16x16x32_bf16 v[96:99], v[200:203], v[224:227], v[96:99]
ds_read_b128 v[172:175], v10 offset:6144
v_mfma_f32_16x16x32_bf16 v[100:103], v[204:207], v[224:227], v[100:103]
ds_read_b64_tr_b16 v[180:181], v15 offset:0
v_mfma_f32_16x16x32_bf16 v[104:107], v[208:211], v[224:227], v[104:107]
ds_read_b64_tr_b16 v[182:183], v15 offset:512
v_mfma_f32_16x16x32_bf16 v[108:111], v[212:215], v[224:227], v[108:111]
ds_read_b64_tr_b16 v[184:185], v14 offset:8192
v_mfma_f32_16x16x32_bf16 v[112:115], v[200:203], v[228:231], v[112:115]
ds_read_b64_tr_b16 v[186:187], v14 offset:8704
v_mfma_f32_16x16x32_bf16 v[116:119], v[204:207], v[228:231], v[116:119]
ds_read_b64_tr_b16 v[188:189], v15 offset:8192
v_mfma_f32_16x16x32_bf16 v[120:123], v[208:211], v[228:231], v[120:123]
ds_read_b64_tr_b16 v[190:191], v15 offset:8704
v_mfma_f32_16x16x32_bf16 v[124:127], v[212:215], v[228:231], v[124:127]
ds_read_b64_tr_b16 v[192:193], v14 offset:16384
v_mfma_f32_16x16x32_bf16 v[128:131], v[200:203], v[232:235], v[128:131]
ds_read_b64_tr_b16 v[194:195], v14 offset:16896
v_mfma_f32_16x16x32_bf16 v[132:135], v[204:207], v[232:235], v[132:135]
ds_read_b64_tr_b16 v[196:197], v15 offset:16384
v_mfma_f32_16x16x32_bf16 v[136:139], v[208:211], v[232:235], v[136:139]
ds_read_b64_tr_b16 v[198:199], v15 offset:16896
v_mfma_f32_16x16x32_bf16 v[140:143], v[212:215], v[232:235], v[140:143]
v_mfma_f32_16x16x32_bf16 v[144:147], v[200:203], v[236:239], v[144:147]
v_mfma_f32_16x16x32_bf16 v[148:151], v[204:207], v[236:239], v[148:151]
v_mfma_f32_16x16x32_bf16 v[152:155], v[208:211], v[236:239], v[152:155]
v_mfma_f32_16x16x32_bf16 v[156:159], v[212:215], v[236:239], v[156:159]
s_waitcnt lgkmcnt(0)
v_mfma_f32_16x16x32_bf16 v[64:67], v[176:179], v[160:163], v[64:67]
ds_read_b128 v[200:203], v11 offset:0
v_mfma_f32_16x16x32_bf16 v[68:71], v[176:179], v[164:167], v[68:71]
ds_read_b64_tr_b16 v[216:217], v14 offset:4096
v_mfma_f32_16x16x32_bf16 v[72:75], v[176:179], v[168:171], v[72:75]
ds_read_b64_tr_b16 v[218:219], v14 offset:4608
v_mfma_f32_16x16x32_bf16 v[76:79], v[176:179], v[172:175], v[76:79]
ds_read_b128 v[204:207], v11 offset:2048
v_mfma_f32_16x16x32_bf16 v[80:83], v[180:183], v[160:163], v[80:83]
ds_read_b128 v[208:211], v11 offset:4096
v_mfma_f32_16x16x32_bf16 v[84:87], v[180:183], v[164:167], v[84:87]
ds_read_b128 v[212:215], v11 offset:6144
v_mfma_f32_16x16x32_bf16 v[88:91], v[180:183], v[168:171], v[88:91]
ds_read_b64_tr_b16 v[220:221], v15 offset:4096
v_mfma_f32_16x16x32_bf16 v[92:95], v[180:183], v[172:175], v[92:95]
ds_read_b64_tr_b16 v[222:223], v15 offset:4608
v_mfma_f32_16x16x32_bf16 v[96:99], v[160:163], v[184:187], v[96:99]
ds_read_b64_tr_b16 v[224:225], v14 offset:12288
v_mfma_f32_16x16x32_bf16 v[100:103], v[164:167], v[184:187], v[100:103]
ds_read_b64_tr_b16 v[226:227], v14 offset:12800
v_mfma_f32_16x16x32_bf16 v[104:107], v[168:171], v[184:187], v[104:107]
ds_read_b64_tr_b16 v[228:229], v15 offset:12288
v_mfma_f32_16x16x32_bf16 v[108:111], v[172:175], v[184:187], v[108:111]
ds_read_b64_tr_b16 v[230:231], v15 offset:12800
v_mfma_f32_16x16x32_bf16 v[112:115], v[160:163], v[188:191], v[112:115]
ds_read_b64_tr_b16 v[232:233], v14 offset:20480
v_mfma_f32_16x16x32_bf16 v[116:119], v[164:167], v[188:191], v[116:119]
ds_read_b64_tr_b16 v[234:235], v14 offset:20992
v_mfma_f32_16x16x32_bf16 v[120:123], v[168:171], v[188:191], v[120:123]
ds_read_b64_tr_b16 v[236:237], v15 offset:20480
v_mfma_f32_16x16x32_bf16 v[124:127], v[172:175], v[188:191], v[124:127]
ds_read_b64_tr_b16 v[238:239], v15 offset:20992
v_mfma_f32_16x16x32_bf16 v[128:131], v[160:163], v[192:195], v[128:131]
v_mfma_f32_16x16x32_bf16 v[132:135], v[164:167], v[192:195], v[132:135]
v_mfma_f32_16x16x32_bf16 v[136:139], v[168:171], v[192:195], v[136:139]
v_mfma_f32_16x16x32_bf16 v[140:143], v[172:175], v[192:195], v[140:143]
v_mfma_f32_16x16x32_bf16 v[144:147], v[160:163], v[196:199], v[144:147]
v_mfma_f32_16x16x32_bf16 v[148:151], v[164:167], v[196:199], v[148:151]
v_mfma_f32_16x16x32_bf16 v[152:155], v[168:171], v[196:199], v[152:155]
v_mfma_f32_16x16x32_bf16 v[156:159], v[172:175], v[196:199], v[156:159]
s_waitcnt lgkmcnt(0)
v_mfma_f32_16x16x32_bf16 v[64:67], v[216:219], v[200:203], v[64:67]
v_mfma_f32_16x16x32_bf16 v[68:71], v[216:219], v[204:207], v[68:71]
v_mfma_f32_16x16x32_bf16 v[72:75], v[216:219], v[208:211], v[72:75]
v_mfma_f32_16x16x32_bf16 v[76:79], v[216:219], v[212:215], v[76:79]
s_barrier
ds_read_b128 v[160:163], v10 offset:40960
v_mfma_f32_16x16x32_bf16 v[80:83], v[220:223], v[200:203], v[80:83]
ds_read_b64_tr_b16 v[176:177], v14 offset:40960
v_mfma_f32_16x16x32_bf16 v[84:87], v[220:223], v[204:207], v[84:87]
ds_read_b64_tr_b16 v[178:179], v14 offset:41472
v_mfma_f32_16x16x32_bf16 v[88:91], v[220:223], v[208:211], v[88:91]
ds_read_b128 v[164:167], v10 offset:43008
v_mfma_f32_16x16x32_bf16 v[92:95], v[220:223], v[212:215], v[92:95]
ds_read_b128 v[168:171], v10 offset:45056
v_mfma_f32_16x16x32_bf16 v[96:99], v[200:203], v[224:227], v[96:99]
ds_read_b128 v[172:175], v10 offset:47104
v_mfma_f32_16x16x32_bf16 v[100:103], v[204:207], v[224:227], v[100:103]
ds_read_b64_tr_b16 v[180:181], v15 offset:40960
v_mfma_f32_16x16x32_bf16 v[104:107], v[208:211], v[224:227], v[104:107]
ds_read_b64_tr_b16 v[182:183], v15 offset:41472
v_mfma_f32_16x16x32_bf16 v[108:111], v[212:215], v[224:227], v[108:111]
ds_read_b64_tr_b16 v[184:185], v14 offset:49152
v_mfma_f32_16x16x32_bf16 v[112:115], v[200:203], v[228:231], v[112:115]
ds_read_b64_tr_b16 v[186:187], v14 offset:49664
v_mfma_f32_16x16x32_bf16 v[116:119], v[204:207], v[228:231], v[116:119]
ds_read_b64_tr_b16 v[188:189], v15 offset:49152
v_mfma_f32_16x16x32_bf16 v[120:123], v[208:211], v[228:231], v[120:123]
ds_read_b64_tr_b16 v[190:191], v15 offset:49664
v_mfma_f32_16x16x32_bf16 v[124:127], v[212:215], v[228:231], v[124:127]
ds_read_b64_tr_b16 v[192:193], v14 offset:57344
v_mfma_f32_16x16x32_bf16 v[128:131], v[200:203], v[232:235], v[128:131]
ds_read_b64_tr_b16 v[194:195], v14 offset:57856
v_mfma_f32_16x16x32_bf16 v[132:135], v[204:207], v[232:235], v[132:135]
ds_read_b64_tr_b16 v[196:197], v15 offset:57344
v_mfma_f32_16x16x32_bf16 v[136:139], v[208:211], v[232:235], v[136:139]
ds_read_b64_tr_b16 v[198:199], v15 offset:57856
v_mfma_f32_16x16x32_bf16 v[140:143], v[212:215], v[232:235], v[140:143]
v_mfma_f32_16x16x32_bf16 v[144:147], v[200:203], v[236:239], v[144:147]
v_mfma_f32_16x16x32_bf16 v[148:151], v[204:207], v[236:239], v[148:151]
v_mfma_f32_16x16x32_bf16 v[152:155], v[208:211], v[236:239], v[152:155]
v_mfma_f32_16x16x32_bf16 v[156:159], v[212:215], v[236:239], v[156:159]
s_waitcnt lgkmcnt(0)
v_mfma_f32_16x16x32_bf16 v[64:67], v[176:179], v[160:163], v[64:67]
ds_read_b128 v[200:203], v11 offset:40960
v_mfma_f32_16x16x32_bf16 v[68:71], v[176:179], v[164:167], v[68:71]
ds_read_b64_tr_b16 v[216:217], v14 offset:45056
v_mfma_f32_16x16x32_bf16 v[72:75], v[176:179], v[168:171], v[72:75]
ds_read_b64_tr_b16 v[218:219], v14 offset:45568
v_mfma_f32_16x16x32_bf16 v[76:79], v[176:179], v[172:175], v[76:79]
ds_read_b128 v[204:207], v11 offset:43008
v_mfma_f32_16x16x32_bf16 v[80:83], v[180:183], v[160:163], v[80:83]
ds_read_b128 v[208:211], v11 offset:45056
v_mfma_f32_16x16x32_bf16 v[84:87], v[180:183], v[164:167], v[84:87]
ds_read_b128 v[212:215], v11 offset:47104
v_mfma_f32_16x16x32_bf16 v[88:91], v[180:183], v[168:171], v[88:91]
ds_read_b64_tr_b16 v[220:221], v15 offset:45056
v_mfma_f32_16x16x32_bf16 v[92:95], v[180:183], v[172:175], v[92:95]
ds_read_b64_tr_b16 v[222:223], v15 offset:45568
v_mfma_f32_16x16x32_bf16 v[96:99], v[160:163], v[184:187], v[96:99]
ds_read_b64_tr_b16 v[224:225], v14 offset:53248
v_mfma_f32_16x16x32_bf16 v[100:103], v[164:167], v[184:187], v[100:103]
ds_read_b64_tr_b16 v[226:227], v14 offset:53760
v_mfma_f32_16x16x32_bf16 v[104:107], v[168:171], v[184:187], v[104:107]
ds_read_b64_tr_b16 v[228:229], v15 offset:53248
v_mfma_f32_16x16x32_bf16 v[108:111], v[172:175], v[184:187], v[108:111]
ds_read_b64_tr_b16 v[230:231], v15 offset:53760
v_mfma_f32_16x16x32_bf16 v[112:115], v[160:163], v[188:191], v[112:115]
ds_read_b64_tr_b16 v[232:233], v14 offset:61440
v_mfma_f32_16x16x32_bf16 v[116:119], v[164:167], v[188:191], v[116:119]
ds_read_b64_tr_b16 v[234:235], v14 offset:61952
v_mfma_f32_16x16x32_bf16 v[120:123], v[168:171], v[188:191], v[120:123]
ds_read_b64_tr_b16 v[236:237], v15 offset:61440
v_mfma_f32_16x16x32_bf16 v[124:127], v[172:175], v[188:191], v[124:127]
ds_read_b64_tr_b16 v[238:239], v15 offset:61952
v_mfma_f32_16x16x32_bf16 v[128:131], v[160:163], v[192:195], v[128:131]
v_mfma_f32_16x16x32_bf16 v[132:135], v[164:167], v[192:195], v[132:135]
v_mfma_f32_16x16x32_bf16 v[136:139], v[168:171], v[192:195], v[136:139]
v_mfma_f32_16x16x32_bf16 v[140:143], v[172:175], v[192:195], v[140:143]
v_mfma_f32_16x16x32_bf16 v[144:147], v[160:163], v[196:199], v[144:147]
v_mfma_f32_16x16x32_bf16 v[148:151], v[164:167], v[196:199], v[148:151]
v_mfma_f32_16x16x32_bf16 v[152:155], v[168:171], v[196:199], v[152:155]
v_mfma_f32_16x16x32_bf16 v[156:159], v[172:175], v[196:199], v[156:159]
s_waitcnt lgkmcnt(0)
s_cmp_eq_u32 s60, 3
s_cbranch_scc1 Lclast
v_mfma_f32_16x16x32_bf16 v[64:67], v[216:219], v[200:203], v[64:67]
v_mfma_f32_16x16x32_bf16 v[68:71], v[216:219], v[204:207], v[68:71]
v_mfma_f32_16x16x32_bf16 v[72:75], v[216:219], v[208:211], v[72:75]
v_mfma_f32_16x16x32_bf16 v[76:79], v[216:219], v[212:215], v[76:79]
s_barrier
ds_read_b128 v[160:163], v8 offset:0
v_mfma_f32_16x16x32_bf16 v[80:83], v[220:223], v[200:203], v[80:83]
ds_read_b64_tr_b16 v[176:177], v12 offset:0
v_mfma_f32_16x16x32_bf16 v[84:87], v[220:223], v[204:207], v[84:87]
ds_read_b64_tr_b16 v[178:179], v12 offset:512
v_mfma_f32_16x16x32_bf16 v[88:91], v[220:223], v[208:211], v[88:91]
ds_read_b128 v[164:167], v8 offset:2048
v_mfma_f32_16x16x32_bf16 v[92:95], v[220:223], v[212:215], v[92:95]
ds_read_b128 v[168:171], v8 offset:4096
v_mfma_f32_16x16x32_bf16 v[96:99], v[200:203], v[224:227], v[96:99]
ds_read_b128 v[172:175], v8 offset:6144
v_mfma_f32_16x16x32_bf16 v[100:103], v[204:207], v[224:227], v[100:103]
ds_read_b64_tr_b16 v[180:181], v13 offset:0
v_mfma_f32_16x16x32_bf16 v[104:107], v[208:211], v[224:227], v[104:107]
ds_read_b64_tr_b16 v[182:183], v13 offset:512
v_mfma_f32_16x16x32_bf16 v[108:111], v[212:215], v[224:227], v[108:111]
ds_read_b64_tr_b16 v[184:185], v12 offset:8192
v_mfma_f32_16x16x32_bf16 v[112:115], v[200:203], v[228:231], v[112:115]
ds_read_b64_tr_b16 v[186:187], v12 offset:8704
v_mfma_f32_16x16x32_bf16 v[116:119], v[204:207], v[228:231], v[116:119]
ds_read_b64_tr_b16 v[188:189], v13 offset:8192
v_mfma_f32_16x16x32_bf16 v[120:123], v[208:211], v[228:231], v[120:123]
ds_read_b64_tr_b16 v[190:191], v13 offset:8704
v_mfma_f32_16x16x32_bf16 v[124:127], v[212:215], v[228:231], v[124:127]
ds_read_b64_tr_b16 v[192:193], v12 offset:16384
v_mfma_f32_16x16x32_bf16 v[128:131], v[200:203], v[232:235], v[128:131]
ds_read_b64_tr_b16 v[194:195], v12 offset:16896
v_mfma_f32_16x16x32_bf16 v[132:135], v[204:207], v[232:235], v[132:135]
ds_read_b64_tr_b16 v[196:197], v13 offset:16384
v_mfma_f32_16x16x32_bf16 v[136:139], v[208:211], v[232:235], v[136:139]
ds_read_b64_tr_b16 v[198:199], v13 offset:16896
v_mfma_f32_16x16x32_bf16 v[140:143], v[212:215], v[232:235], v[140:143]
v_mfma_f32_16x16x32_bf16 v[144:147], v[200:203], v[236:239], v[144:147]
v_mfma_f32_16x16x32_bf16 v[148:151], v[204:207], v[236:239], v[148:151]
v_mfma_f32_16x16x32_bf16 v[152:155], v[208:211], v[236:239], v[152:155]
v_mfma_f32_16x16x32_bf16 v[156:159], v[212:215], v[236:239], v[156:159]
s_add_u32 s60, s60, 1
s_branch Lcloop
Lclast:
v_mfma_f32_16x16x32_bf16 v[64:67], v[216:219], v[200:203], v[64:67]
v_mfma_f32_16x16x32_bf16 v[68:71], v[216:219], v[204:207], v[68:71]
v_mfma_f32_16x16x32_bf16 v[72:75], v[216:219], v[208:211], v[72:75]
v_mfma_f32_16x16x32_bf16 v[76:79], v[216:219], v[212:215], v[76:79]
v_mfma_f32_16x16x32_bf16 v[80:83], v[220:223], v[200:203], v[80:83]
v_mfma_f32_16x16x32_bf16 v[84:87], v[220:223], v[204:207], v[84:87]
v_mfma_f32_16x16x32_bf16 v[88:91], v[220:223], v[208:211], v[88:91]
v_mfma_f32_16x16x32_bf16 v[92:95], v[220:223], v[212:215], v[92:95]
v_mfma_f32_16x16x32_bf16 v[96:99], v[200:203], v[224:227], v[96:99]
v_mfma_f32_16x16x32_bf16 v[100:103], v[204:207], v[224:227], v[100:103]
v_mfma_f32_16x16x32_bf16 v[104:107], v[208:211], v[224:227], v[104:107]
v_mfma_f32_16x16x32_bf16 v[108:111], v[212:215], v[224:227], v[108:111]
v_mfma_f32_16x16x32_bf16 v[112:115], v[200:203], v[228:231], v[112:115]
v_mfma_f32_16x16x32_bf16 v[116:119], v[204:207], v[228:231], v[116:119]
v_mfma_f32_16x16x32_bf16 v[120:123], v[208:211], v[228:231], v[120:123]
v_mfma_f32_16x16x32_bf16 v[124:127], v[212:215], v[228:231], v[124:127]
v_mfma_f32_16x16x32_bf16 v[128:131], v[200:203], v[232:235], v[128:131]
v_mfma_f32_16x16x32_bf16 v[132:135], v[204:207], v[232:235], v[132:135]
v_mfma_f32_16x16x32_bf16 v[136:139], v[208:211], v[232:235], v[136:139]
v_mfma_f32_16x16x32_bf16 v[140:143], v[212:215], v[232:235], v[140:143]
v_mfma_f32_16x16x32_bf16 v[144:147], v[200:203], v[236:239], v[144:147]
v_mfma_f32_16x16x32_bf16 v[148:151], v[204:207], v[236:239], v[148:151]
v_mfma_f32_16x16x32_bf16 v[152:155], v[208:211], v[236:239], v[152:155]
v_mfma_f32_16x16x32_bf16 v[156:159], v[212:215], v[236:239], v[156:159]
s_nop 7
v_pk_mul_f32 v[24:25], v[96:97], s[56:57]
v_pk_mul_f32 v[26:27], v[98:99], s[56:57]
v_pk_mul_f32 v[28:29], v[100:101], s[56:57]
v_pk_mul_f32 v[30:31], v[102:103], s[56:57]
v_exp_f32_e64 v24, v24 clamp
v_exp_f32_e64 v25, v25 clamp
v_exp_f32_e64 v26, v26 clamp
v_exp_f32_e64 v27, v27 clamp
v_exp_f32_e64 v28, v28 clamp
v_exp_f32_e64 v29, v29 clamp
v_exp_f32_e64 v30, v30 clamp
v_exp_f32_e64 v31, v31 clamp
v_max_f32 v96, 0, v96
v_max_f32 v97, 0, v97
v_max_f32 v98, 0, v98
v_max_f32 v99, 0, v99
v_max_f32 v100, 0, v100
v_max_f32 v101, 0, v101
v_max_f32 v102, 0, v102
v_max_f32 v103, 0, v103
v_pk_add_f32 v[96:97], v[96:97], v[24:25]
v_pk_add_f32 v[98:99], v[98:99], v[26:27]
v_pk_add_f32 v[100:101], v[100:101], v[28:29]
v_pk_add_f32 v[102:103], v[102:103], v[30:31]
v_pk_add_f32 v[96:97], v[96:97], s[58:59]
v_pk_add_f32 v[98:99], v[98:99], s[58:59]
v_pk_add_f32 v[100:101], v[100:101], s[58:59]
v_pk_add_f32 v[102:103], v[102:103], s[58:59]
v_cvt_pk_bf16_f32 v160, v96, v97
v_cvt_pk_bf16_f32 v161, v98, v99
v_cvt_pk_bf16_f32 v162, v100, v101
v_cvt_pk_bf16_f32 v163, v102, v103
v_pk_mul_f32 v[24:25], v[104:105], s[56:57]
v_pk_mul_f32 v[26:27], v[106:107], s[56:57]
v_pk_mul_f32 v[28:29], v[108:109], s[56:57]
v_pk_mul_f32 v[30:31], v[110:111], s[56:57]
v_exp_f32_e64 v24, v24 clamp
v_exp_f32_e64 v25, v25 clamp
v_exp_f32_e64 v26, v26 clamp
v_exp_f32_e64 v27, v27 clamp
v_exp_f32_e64 v28, v28 clamp
v_exp_f32_e64 v29, v29 clamp
v_exp_f32_e64 v30, v30 clamp
v_exp_f32_e64 v31, v31 clamp
v_max_f32 v104, 0, v104
v_max_f32 v105, 0, v105
v_max_f32 v106, 0, v106
v_max_f32 v107, 0, v107
v_max_f32 v108, 0, v108
v_max_f32 v109, 0, v109
v_max_f32 v110, 0, v110
v_max_f32 v111, 0, v111
v_pk_add_f32 v[104:105], v[104:105], v[24:25]
v_pk_add_f32 v[106:107], v[106:107], v[26:27]
v_pk_add_f32 v[108:109], v[108:109], v[28:29]
v_pk_add_f32 v[110:111], v[110:111], v[30:31]
v_pk_add_f32 v[104:105], v[104:105], s[58:59]
v_pk_add_f32 v[106:107], v[106:107], s[58:59]
v_pk_add_f32 v[108:109], v[108:109], s[58:59]
v_pk_add_f32 v[110:111], v[110:111], s[58:59]
v_cvt_pk_bf16_f32 v164, v104, v105
v_cvt_pk_bf16_f32 v165, v106, v107
v_cvt_pk_bf16_f32 v166, v108, v109
v_cvt_pk_bf16_f32 v167, v110, v111
v_pk_mul_f32 v[24:25], v[112:113], s[56:57]
v_pk_mul_f32 v[26:27], v[114:115], s[56:57]
v_pk_mul_f32 v[28:29], v[116:117], s[56:57]
v_pk_mul_f32 v[30:31], v[118:119], s[56:57]
v_exp_f32_e64 v24, v24 clamp
v_exp_f32_e64 v25, v25 clamp
v_exp_f32_e64 v26, v26 clamp
v_exp_f32_e64 v27, v27 clamp
v_exp_f32_e64 v28, v28 clamp
v_exp_f32_e64 v29, v29 clamp
v_exp_f32_e64 v30, v30 clamp
v_exp_f32_e64 v31, v31 clamp
v_max_f32 v112, 0, v112
v_max_f32 v113, 0, v113
v_max_f32 v114, 0, v114
v_max_f32 v115, 0, v115
v_max_f32 v116, 0, v116
v_max_f32 v117, 0, v117
v_max_f32 v118, 0, v118
v_max_f32 v119, 0, v119
v_pk_add_f32 v[112:113], v[112:113], v[24:25]
v_pk_add_f32 v[114:115], v[114:115], v[26:27]
v_pk_add_f32 v[116:117], v[116:117], v[28:29]
v_pk_add_f32 v[118:119], v[118:119], v[30:31]
v_pk_add_f32 v[112:113], v[112:113], s[58:59]
v_pk_add_f32 v[114:115], v[114:115], s[58:59]
v_pk_add_f32 v[116:117], v[116:117], s[58:59]
v_pk_add_f32 v[118:119], v[118:119], s[58:59]
v_cvt_pk_bf16_f32 v168, v112, v113
v_cvt_pk_bf16_f32 v169, v114, v115
v_cvt_pk_bf16_f32 v170, v116, v117
v_cvt_pk_bf16_f32 v171, v118, v119
v_pk_mul_f32 v[24:25], v[120:121], s[56:57]
v_pk_mul_f32 v[26:27], v[122:123], s[56:57]
v_pk_mul_f32 v[28:29], v[124:125], s[56:57]
v_pk_mul_f32 v[30:31], v[126:127], s[56:57]
v_exp_f32_e64 v24, v24 clamp
v_exp_f32_e64 v25, v25 clamp
v_exp_f32_e64 v26, v26 clamp
v_exp_f32_e64 v27, v27 clamp
v_exp_f32_e64 v28, v28 clamp
v_exp_f32_e64 v29, v29 clamp
v_exp_f32_e64 v30, v30 clamp
v_exp_f32_e64 v31, v31 clamp
v_max_f32 v120, 0, v120
v_max_f32 v121, 0, v121
v_max_f32 v122, 0, v122
v_max_f32 v123, 0, v123
v_max_f32 v124, 0, v124
v_max_f32 v125, 0, v125
v_max_f32 v126, 0, v126
v_max_f32 v127, 0, v127
v_pk_add_f32 v[120:121], v[120:121], v[24:25]
v_pk_add_f32 v[122:123], v[122:123], v[26:27]
v_pk_add_f32 v[124:125], v[124:125], v[28:29]
v_pk_add_f32 v[126:127], v[126:127], v[30:31]
v_pk_add_f32 v[120:121], v[120:121], s[58:59]
v_pk_add_f32 v[122:123], v[122:123], s[58:59]
v_pk_add_f32 v[124:125], v[124:125], s[58:59]
v_pk_add_f32 v[126:127], v[126:127], s[58:59]
v_cvt_pk_bf16_f32 v172, v120, v121
v_cvt_pk_bf16_f32 v173, v122, v123
v_cvt_pk_bf16_f32 v174, v124, v125
v_cvt_pk_bf16_f32 v175, v126, v127
v_cvt_pk_bf16_f32 v176, v128, v129
v_cvt_pk_bf16_f32 v177, v130, v131
v_cvt_pk_bf16_f32 v178, v132, v133
v_cvt_pk_bf16_f32 v179, v134, v135
v_cvt_pk_bf16_f32 v180, v136, v137
v_cvt_pk_bf16_f32 v181, v138, v139
v_cvt_pk_bf16_f32 v182, v140, v141
v_cvt_pk_bf16_f32 v183, v142, v143
v_cvt_pk_bf16_f32 v184, v144, v145
v_cvt_pk_bf16_f32 v185, v146, v147
v_cvt_pk_bf16_f32 v186, v148, v149
v_cvt_pk_bf16_f32 v187, v150, v151
v_cvt_pk_bf16_f32 v188, v152, v153
v_cvt_pk_bf16_f32 v189, v154, v155
v_cvt_pk_bf16_f32 v190, v156, v157
v_cvt_pk_bf16_f32 v191, v158, v159
v_mov_b32 v192, 0x3f803f80
v_mov_b32 v193, 0x3f803f80
v_mov_b32 v194, 0x3f803f80
v_mov_b32 v195, 0x3f803f80
s_nop 1
v_mfma_f32_16x16x32_bf16 v[96:99], v[160:163], v[176:179], 0
v_mfma_f32_16x16x32_bf16 v[100:103], v[160:163], v[184:187], 0
v_mfma_f32_16x16x32_bf16 v[112:115], v[160:163], v[192:195], 0
v_mfma_f32_16x16x32_bf16 v[104:107], v[168:171], v[176:179], 0
v_mfma_f32_16x16x32_bf16 v[108:111], v[168:171], v[184:187], 0
v_mfma_f32_16x16x32_bf16 v[116:119], v[168:171], v[192:195], 0
v_mfma_f32_16x16x32_bf16 v[96:99], v[164:167], v[180:183], v[96:99]
v_mfma_f32_16x16x32_bf16 v[100:103], v[164:167], v[188:191], v[100:103]
v_mfma_f32_16x16x32_bf16 v[112:115], v[164:167], v[192:195], v[112:115]
v_mfma_f32_16x16x32_bf16 v[104:107], v[172:175], v[180:183], v[104:107]
v_mfma_f32_16x16x32_bf16 v[108:111], v[172:175], v[188:191], v[108:111]
v_mfma_f32_16x16x32_bf16 v[116:119], v[172:175], v[192:195], v[116:119]
v_mov_b32 v30, 0
v_mov_b32 v31, 1
s_mul_i32 s55, s50, 3072
s_add_u32 s55, s55, 134400
s_xor_b32 s61, s50, 1
s_mul_i32 s61, s61, 3072
s_add_u32 s61, s61, 134400
v_lshlrev_b32 v6, 4, v0
v_add_u32 v8, s55, v6
v_add_u32 v9, s61, v6
s_lshl_b32 s55, s50, 2
v_mov_b32 v13, s55
s_xor_b32 s55, s55, 4
v_mov_b32 v14, s55
s_lshl_b32 s55, s49, 1
s_add_u32 s55, s55, s54
s_lshl_b32 s55, s55, 4
s_add_u32 s55, s55, s48
s_lshl_b32 s63, s55, 11
s_lshl_b32 s61, s53, 10
s_add_u32 s63, s63, s61
s_add_u32 s63, s63, 8388608
s_lshl_b32 s62, s55, 7
s_lshl_b32 s61, s53, 6
s_add_u32 s62, s62, s61
s_add_u32 s62, s62, 10485760
v_lshlrev_b32 v7, 4, v3
s_nop 3
s_cmp_eq_u32 s53, 0
s_cbranch_scc1 Lred0
ds_write_b128 v8, v[96:99] offset:0
ds_write_b128 v8, v[100:103] offset:1024
ds_write_b128 v8, v[112:115] offset:2048
s_waitcnt lgkmcnt(0)
ds_write_b32 v13, v31 offset:21232
s_mov_b32 s61, 0
Lsp1:
ds_read_b32 v28, v14 offset:21232
s_waitcnt lgkmcnt(0)
v_readfirstlane_b32 s60, v28
s_add_u32 s61, s61, 1
s_cmp_eq_u32 s60, 1
s_cbranch_scc1 Lsx2
s_cmp_lt_u32 s61, 1048576
s_cbranch_scc1 Lsp1
Lsx2:
ds_read_b128 v[32:35], v9 offset:0
ds_read_b128 v[36:39], v9 offset:1024
ds_read_b128 v[40:43], v9 offset:2048
s_waitcnt lgkmcnt(0)
v_add_f32 v104, v104, v32
v_add_f32 v105, v105, v33
v_add_f32 v106, v106, v34
v_add_f32 v107, v107, v35
v_add_f32 v108, v108, v36
v_add_f32 v109, v109, v37
v_add_f32 v110, v110, v38
v_add_f32 v111, v111, v39
v_add_f32 v116, v116, v40
v_add_f32 v117, v117, v41
v_add_f32 v118, v118, v42
v_add_f32 v119, v119, v43
v_cvt_pk_bf16_f32 v44, v104, v105
v_cvt_pk_bf16_f32 v45, v106, v107
v_cvt_pk_bf16_f32 v46, v108, v109
v_cvt_pk_bf16_f32 v47, v110, v111
buffer_store_dwordx4 v[44:47], v6, s[36:39], s63 offen sc1
v_cmp_eq_u32 vcc, 0, v2
s_and_saveexec_b64 s[64:65], vcc
buffer_store_dwordx4 v[116:119], v7, s[36:39], s62 offen sc1
s_mov_b64 exec, s[64:65]
s_branch Lredj
Lred0:
ds_write_b128 v8, v[104:107] offset:0
ds_write_b128 v8, v[108:111] offset:1024
ds_write_b128 v8, v[116:119] offset:2048
s_waitcnt lgkmcnt(0)
ds_write_b32 v13, v31 offset:21232
s_mov_b32 s61, 0
Lsp3:
ds_read_b32 v28, v14 offset:21232
s_waitcnt lgkmcnt(0)
v_readfirstlane_b32 s60, v28
s_add_u32 s61, s61, 1
s_cmp_eq_u32 s60, 1
s_cbranch_scc1 Lsx4
s_cmp_lt_u32 s61, 1048576
s_cbranch_scc1 Lsp3
Lsx4:
ds_read_b128 v[32:35], v9 offset:0
ds_read_b128 v[36:39], v9 offset:1024
ds_read_b128 v[40:43], v9 offset:2048
s_waitcnt lgkmcnt(0)
v_add_f32 v96, v96, v32
v_add_f32 v97, v97, v33
v_add_f32 v98, v98, v34
v_add_f32 v99, v99, v35
v_add_f32 v100, v100, v36
v_add_f32 v101, v101, v37
v_add_f32 v102, v102, v38
v_add_f32 v103, v103, v39
v_add_f32 v112, v112, v40
v_add_f32 v113, v113, v41
v_add_f32 v114, v114, v42
v_add_f32 v115, v115, v43
v_cvt_pk_bf16_f32 v44, v96, v97
v_cvt_pk_bf16_f32 v45, v98, v99
v_cvt_pk_bf16_f32 v46, v100, v101
v_cvt_pk_bf16_f32 v47, v102, v103
buffer_store_dwordx4 v[44:47], v6, s[36:39], s63 offen sc1
v_cmp_eq_u32 vcc, 0, v2
s_and_saveexec_b64 s[64:65], vcc
buffer_store_dwordx4 v[112:115], v7, s[36:39], s62 offen sc1
s_mov_b64 exec, s[64:65]
Lredj:
s_lshl_b32 s55, s49, 4
s_add_u32 s55, s55, s48
s_lshl_b32 s55, s55, 7
s_add_u32 s55, s55, 12058624
v_mov_b32 v28, s55
s_waitcnt vmcnt(0)
s_mov_b64 exec, 1
ds_add_rtn_u32 v29, v30, v31 offset:42484
s_waitcnt lgkmcnt(0)
v_readfirstlane_b32 s60, v29
s_cmp_eq_u32 s60, 3
s_cbranch_scc0 Lcl5
buffer_store_dword v31, v28, s[36:39], 0 offen sc1
Lcl5:
s_mov_b64 exec, -1
Lred1:
s_lshl_b32 s55, s48, 7
s_lshl_b32 s61, s53, 6
s_add_u32 s55, s55, s61
v_add_u32 v5, s55, v2
v_lshlrev_b32 v5, 11, v5
s_lshl_b32 s55, s49, 7
s_lshl_b32 s61, s54, 6
s_add_u32 s55, s55, s61
v_and_b32 v6, 1, v3
v_lshlrev_b32 v6, 5, v6
v_lshrrev_b32 v7, 1, v3
v_lshl_add_u32 v6, v7, 4, v6
v_add3_u32 v5, v5, v6, s55
s_mul_i32 s55, s50, 4608
s_add_u32 s55, s55, 134400
s_xor_b32 s61, s50, 1
s_mul_i32 s61, s61, 4608
s_add_u32 s61, s61, 134400
v_lshlrev_b32 v6, 4, v0
v_add_u32 v8, s55, v6
v_add_u32 v9, s61, v6
v_and_b32 v7, 7, v0
v_lshlrev_b32 v7, 4, v7
s_add_u32 s55, s55, 4096
v_add_u32 v10, s55, v7
v_lshlrev_b32 v7, 4, v3
v_add_u32 v11, s55, v7
s_add_u32 s61, s61, 4096
v_add_u32 v12, s61, v7
s_lshl_b32 s55, s50, 2
v_mov_b32 v13, s55
s_xor_b32 s55, s55, 4
v_mov_b32 v14, s55
s_lshl_b32 s55, s49, 1
s_add_u32 s55, s55, s54
s_lshl_b32 s55, s55, 4
s_lshl_b32 s61, s53, 3
s_add_u32 s55, s55, s61
s_lshl_b32 s68, s55, 11
s_add_u32 s68, s68, 8388608
s_lshl_b32 s69, s55, 7
s_add_u32 s69, s69, 10485760
v_lshrrev_b32 v6, 2, v2
v_cmp_eq_u32 vcc, v6, v3
v_and_b32 v6, 1, v2
v_lshlrev_b32 v6, 4, v6
v_mov_b32 v7, 0x3f80
v_lshlrev_b32 v6, v6, v7
v_cndmask_b32 v6, 0, v6, vcc
v_bfe_u32 v7, v2, 1, 1
v_cmp_eq_u32 vcc, 0, v7
v_mov_b32 v248, 0
v_mov_b32 v249, 0
v_mov_b32 v250, 0
v_mov_b32 v251, 0
v_mov_b32 v252, 0
v_mov_b32 v253, 0
v_mov_b32 v254, 0
v_mov_b32 v255, 0
v_cndmask_b32 v248, 0, v6, vcc
v_cndmask_b32_e64 v249, v6, 0, vcc
v_mov_b32 v254, v248
v_mov_b32 v255, v249
v_pk_mul_f32 v[32:33], v[64:65], s[56:57]
v_pk_mul_f32 v[34:35], v[66:67], s[56:57]
v_pk_mul_f32 v[36:37], v[80:81], s[56:57]
v_pk_mul_f32 v[38:39], v[82:83], s[56:57]
v_exp_f32_e64 v32, v32 clamp
v_exp_f32_e64 v33, v33 clamp
v_exp_f32_e64 v34, v34 clamp
v_exp_f32_e64 v35, v35 clamp
v_exp_f32_e64 v36, v36 clamp
v_exp_f32_e64 v37, v37 clamp
v_exp_f32_e64 v38, v38 clamp
v_exp_f32_e64 v39, v39 clamp
v_max_f32 v64, 0, v64
v_max_f32 v65, 0, v65
v_max_f32 v66, 0, v66
v_max_f32 v67, 0, v67
v_max_f32 v80, 0, v80
v_max_f32 v81, 0, v81
v_max_f32 v82, 0, v82
v_max_f32 v83, 0, v83
v_pk_add_f32 v[64:65], v[64:65], v[32:33]
v_pk_add_f32 v[66:67], v[66:67], v[34:35]
v_pk_add_f32 v[80:81], v[80:81], v[36:37]
v_pk_add_f32 v[82:83], v[82:83], v[38:39]
v_pk_add_f32 v[64:65], v[64:65], s[58:59]
v_pk_add_f32 v[66:67], v[66:67], s[58:59]
v_pk_add_f32 v[80:81], v[80:81], s[58:59]
v_pk_add_f32 v[82:83], v[82:83], s[58:59]
v_cvt_pk_bf16_f32 v200, v64, v65
v_cvt_pk_bf16_f32 v201, v66, v67
v_cvt_pk_bf16_f32 v202, v80, v81
v_cvt_pk_bf16_f32 v203, v82, v83
v_pk_mul_f32 v[32:33], v[68:69], s[56:57]
v_pk_mul_f32 v[34:35], v[70:71], s[56:57]
v_pk_mul_f32 v[36:37], v[84:85], s[56:57]
v_pk_mul_f32 v[38:39], v[86:87], s[56:57]
v_exp_f32_e64 v32, v32 clamp
v_exp_f32_e64 v33, v33 clamp
v_exp_f32_e64 v34, v34 clamp
v_exp_f32_e64 v35, v35 clamp
v_exp_f32_e64 v36, v36 clamp
v_exp_f32_e64 v37, v37 clamp
v_exp_f32_e64 v38, v38 clamp
v_exp_f32_e64 v39, v39 clamp
v_max_f32 v68, 0, v68
v_max_f32 v69, 0, v69
v_max_f32 v70, 0, v70
v_max_f32 v71, 0, v71
v_max_f32 v84, 0, v84
v_max_f32 v85, 0, v85
v_max_f32 v86, 0, v86
v_max_f32 v87, 0, v87
v_pk_add_f32 v[68:69], v[68:69], v[32:33]
v_pk_add_f32 v[70:71], v[70:71], v[34:35]
v_pk_add_f32 v[84:85], v[84:85], v[36:37]
v_pk_add_f32 v[86:87], v[86:87], v[38:39]
v_pk_add_f32 v[68:69], v[68:69], s[58:59]
v_pk_add_f32 v[70:71], v[70:71], s[58:59]
v_pk_add_f32 v[84:85], v[84:85], s[58:59]
v_pk_add_f32 v[86:87], v[86:87], s[58:59]
v_cvt_pk_bf16_f32 v204, v68, v69
v_cvt_pk_bf16_f32 v205, v70, v71
v_cvt_pk_bf16_f32 v206, v84, v85
v_cvt_pk_bf16_f32 v207, v86, v87
v_pk_mul_f32 v[32:33], v[72:73], s[56:57]
v_pk_mul_f32 v[34:35], v[74:75], s[56:57]
v_pk_mul_f32 v[36:37], v[88:89], s[56:57]
v_pk_mul_f32 v[38:39], v[90:91], s[56:57]
v_exp_f32_e64 v32, v32 clamp
v_exp_f32_e64 v33, v33 clamp
v_exp_f32_e64 v34, v34 clamp
v_exp_f32_e64 v35, v35 clamp
v_exp_f32_e64 v36, v36 clamp
v_exp_f32_e64 v37, v37 clamp
v_exp_f32_e64 v38, v38 clamp
v_exp_f32_e64 v39, v39 clamp
v_max_f32 v72, 0, v72
v_max_f32 v73, 0, v73
v_max_f32 v74, 0, v74
v_max_f32 v75, 0, v75
v_max_f32 v88, 0, v88
v_max_f32 v89, 0, v89
v_max_f32 v90, 0, v90
v_max_f32 v91, 0, v91
v_pk_add_f32 v[72:73], v[72:73], v[32:33]
v_pk_add_f32 v[74:75], v[74:75], v[34:35]
v_pk_add_f32 v[88:89], v[88:89], v[36:37]
v_pk_add_f32 v[90:91], v[90:91], v[38:39]
v_pk_add_f32 v[72:73], v[72:73], s[58:59]
v_pk_add_f32 v[74:75], v[74:75], s[58:59]
v_pk_add_f32 v[88:89], v[88:89], s[58:59]
v_pk_add_f32 v[90:91], v[90:91], s[58:59]
v_cvt_pk_bf16_f32 v208, v72, v73
v_cvt_pk_bf16_f32 v209, v74, v75
v_cvt_pk_bf16_f32 v210, v88, v89
v_cvt_pk_bf16_f32 v211, v90, v91
v_pk_mul_f32 v[32:33], v[76:77], s[56:57]
v_pk_mul_f32 v[34:35], v[78:79], s[56:57]
v_pk_mul_f32 v[36:37], v[92:93], s[56:57]
v_pk_mul_f32 v[38:39], v[94:95], s[56:57]
v_exp_f32_e64 v32, v32 clamp
v_exp_f32_e64 v33, v33 clamp
v_exp_f32_e64 v34, v34 clamp
v_exp_f32_e64 v35, v35 clamp
v_exp_f32_e64 v36, v36 clamp
v_exp_f32_e64 v37, v37 clamp
v_exp_f32_e64 v38, v38 clamp
v_exp_f32_e64 v39, v39 clamp
v_max_f32 v76, 0, v76
v_max_f32 v77, 0, v77
v_max_f32 v78, 0, v78
v_max_f32 v79, 0, v79
v_max_f32 v92, 0, v92
v_max_f32 v93, 0, v93
v_max_f32 v94, 0, v94
v_max_f32 v95, 0, v95
v_pk_add_f32 v[76:77], v[76:77], v[32:33]
v_pk_add_f32 v[78:79], v[78:79], v[34:35]
v_pk_add_f32 v[92:93], v[92:93], v[36:37]
v_pk_add_f32 v[94:95], v[94:95], v[38:39]
v_pk_add_f32 v[76:77], v[76:77], s[58:59]
v_pk_add_f32 v[78:79], v[78:79], s[58:59]
v_pk_add_f32 v[92:93], v[92:93], s[58:59]
v_pk_add_f32 v[94:95], v[94:95], s[58:59]
v_cvt_pk_bf16_f32 v212, v76, v77
v_cvt_pk_bf16_f32 v213, v78, v79
v_cvt_pk_bf16_f32 v214, v92, v93
v_cvt_pk_bf16_f32 v215, v94, v95
s_cmp_eq_u32 s50, 1
s_cbranch_scc0 Lkvw
s_mov_b32 s61, 0
v_mov_b32 v29, 0
Lzl6:
buffer_load_dword v28, v29, s[40:43], 0 offen sc1
s_waitcnt vmcnt(0)
v_readfirstlane_b32 s60, v28
s_add_u32 s61, s61, 1
s_cmp_ge_u32 s60, 256
s_cbranch_scc1 Lzx7
s_cmp_lt_u32 s61, 131072
s_cbranch_scc1 Lzl6
Lzx7:
s_lshl_b32 s55, s49, 11
s_add_u32 s55, s55, 12058624
v_lshl_add_u32 v15, v2, 7, s55
s_mov_b32 s61, 0
Lpl8:
buffer_load_dword v28, v15, s[36:39], 0 offen sc1
ds_read_b32 v29, v30 offset:42484
s_waitcnt vmcnt(0) lgkmcnt(0)
v_cmp_ne_u32 vcc, 1, v28
v_readfirstlane_b32 s62, v29
s_add_u32 s61, s61, 1
s_nop 2
s_cmp_eq_u64 vcc, 0
s_cselect_b32 s60, 1, 0
s_cmp_ge_u32 s62, 4
s_cselect_b32 s62, 1, 0
s_and_b32 s60, s60, s62
s_cbranch_scc1 Lpx9
s_cmp_lt_u32 s61, 131072
s_cbranch_scc1 Lpl8
Lpx9:
ds_write_b32 v30, v31 offset:42488
s_branch Lkvg
Lkvw:
s_mov_b32 s61, 0
Lsp10:
ds_read_b32 v28, v30 offset:42488
s_waitcnt lgkmcnt(0)
v_readfirstlane_b32 s60, v28
s_add_u32 s61, s61, 1
s_cmp_eq_u32 s60, 1
s_cbranch_scc1 Lsx11
s_cmp_lt_u32 s61, 1048576
s_cbranch_scc1 Lsp10
Lsx11:
Lkvg:
v_lshlrev_b32 v6, 4, v0
buffer_load_dwordx4 v[120:123], v6, s[36:39], s69 offen sc1
buffer_load_dwordx4 v[128:131], v6, s[36:39], s68 offen offset:0 sc1
buffer_load_dwordx4 v[132:135], v6, s[36:39], s68 offen offset:1024 sc1
s_add_u32 s68, s68, 2048
buffer_load_dwordx4 v[136:139], v6, s[36:39], s68 offen offset:0 sc1
buffer_load_dwordx4 v[140:143], v6, s[36:39], s68 offen offset:1024 sc1
s_add_u32 s68, s68, 2048
buffer_load_dwordx4 v[144:147], v6, s[36:39], s68 offen offset:0 sc1
buffer_load_dwordx4 v[148:151], v6, s[36:39], s68 offen offset:1024 sc1
s_add_u32 s68, s68, 2048
buffer_load_dwordx4 v[152:155], v6, s[36:39], s68 offen offset:0 sc1
buffer_load_dwordx4 v[156:159], v6, s[36:39], s68 offen offset:1024 sc1
s_add_u32 s68, s68, 2048
buffer_load_dwordx4 v[160:163], v6, s[36:39], s68 offen offset:0 sc1
buffer_load_dwordx4 v[164:167], v6, s[36:39], s68 offen offset:1024 sc1
s_add_u32 s68, s68, 2048
buffer_load_dwordx4 v[168:171], v6, s[36:39], s68 offen offset:0 sc1
buffer_load_dwordx4 v[172:175], v6, s[36:39], s68 offen offset:1024 sc1
s_add_u32 s68, s68, 2048
buffer_load_dwordx4 v[176:179], v6, s[36:39], s68 offen offset:0 sc1
buffer_load_dwordx4 v[180:183], v6, s[36:39], s68 offen offset:1024 sc1
s_add_u32 s68, s68, 2048
buffer_load_dwordx4 v[184:187], v6, s[36:39], s68 offen offset:0 sc1
buffer_load_dwordx4 v[188:191], v6, s[36:39], s68 offen offset:1024 sc1
s_add_u32 s68, s68, 2048
s_waitcnt vmcnt(16)
v_add_f32_dpp v120, v120, v120 row_ror:8 row_mask:0xf bank_mask:0xf
v_add_f32_dpp v121, v121, v121 row_ror:8 row_mask:0xf bank_mask:0xf
v_add_f32_dpp v122, v122, v122 row_ror:8 row_mask:0xf bank_mask:0xf
v_add_f32_dpp v123, v123, v123 row_ror:8 row_mask:0xf bank_mask:0xf
v_mov_b32 v124, v120
v_mov_b32 v125, v121
v_mov_b32 v126, v122
v_mov_b32 v127, v123
s_nop 1
v_permlane16_swap_b32 v120, v124
v_permlane16_swap_b32 v121, v125
v_permlane16_swap_b32 v122, v126
v_permlane16_swap_b32 v123, v127
s_nop 1
v_add_f32 v120, v120, v124
v_add_f32 v121, v121, v125
v_add_f32 v122, v122, v126
v_add_f32 v123, v123, v127
v_mov_b32 v124, v120
v_mov_b32 v125, v121
v_mov_b32 v126, v122
v_mov_b32 v127, v123
s_nop 1
v_permlane32_swap_b32 v120, v124
v_permlane32_swap_b32 v121, v125
v_permlane32_swap_b32 v122, v126
v_permlane32_swap_b32 v123, v127
s_nop 1
v_add_f32 v120, v120, v124
v_add_f32 v121, v121, v125
v_add_f32 v122, v122, v126
v_add_f32 v123, v123, v127
ds_write_b128 v10, v[120:123]
s_waitcnt vmcnt(14)
v_mfma_f32_16x16x32_bf16 v[64:67], v[248:251], v[128:131], 0
v_mfma_f32_16x16x32_bf16 v[68:71], v[252:255], v[128:131], 0
v_mfma_f32_16x16x32_bf16 v[72:75], v[248:251], v[132:135], 0
v_mfma_f32_16x16x32_bf16 v[76:79], v[252:255], v[132:135], 0
s_waitcnt vmcnt(12)
v_mfma_f32_16x16x32_bf16 v[64:67], v[248:251], v[136:139], v[64:67]
v_mfma_f32_16x16x32_bf16 v[68:71], v[252:255], v[136:139], v[68:71]
v_mfma_f32_16x16x32_bf16 v[72:75], v[248:251], v[140:143], v[72:75]
v_mfma_f32_16x16x32_bf16 v[76:79], v[252:255], v[140:143], v[76:79]
s_waitcnt vmcnt(10)
v_mfma_f32_16x16x32_bf16 v[64:67], v[248:251], v[144:147], v[64:67]
v_mfma_f32_16x16x32_bf16 v[68:71], v[252:255], v[144:147], v[68:71]
v_mfma_f32_16x16x32_bf16 v[72:75], v[248:251], v[148:151], v[72:75]
v_mfma_f32_16x16x32_bf16 v[76:79], v[252:255], v[148:151], v[76:79]
s_waitcnt vmcnt(8)
v_mfma_f32_16x16x32_bf16 v[64:67], v[248:251], v[152:155], v[64:67]
v_mfma_f32_16x16x32_bf16 v[68:71], v[252:255], v[152:155], v[68:71]
v_mfma_f32_16x16x32_bf16 v[72:75], v[248:251], v[156:159], v[72:75]
v_mfma_f32_16x16x32_bf16 v[76:79], v[252:255], v[156:159], v[76:79]
s_waitcnt vmcnt(6)
v_mfma_f32_16x16x32_bf16 v[64:67], v[248:251], v[160:163], v[64:67]
v_mfma_f32_16x16x32_bf16 v[68:71], v[252:255], v[160:163], v[68:71]
v_mfma_f32_16x16x32_bf16 v[72:75], v[248:251], v[164:167], v[72:75]
v_mfma_f32_16x16x32_bf16 v[76:79], v[252:255], v[164:167], v[76:79]
s_waitcnt vmcnt(4)
v_mfma_f32_16x16x32_bf16 v[64:67], v[248:251], v[168:171], v[64:67]
v_mfma_f32_16x16x32_bf16 v[68:71], v[252:255], v[168:171], v[68:71]
v_mfma_f32_16x16x32_bf16 v[72:75], v[248:251], v[172:175], v[72:75]
v_mfma_f32_16x16x32_bf16 v[76:79], v[252:255], v[172:175], v[76:79]
s_waitcnt vmcnt(2)
v_mfma_f32_16x16x32_bf16 v[64:67], v[248:251], v[176:179], v[64:67]
v_mfma_f32_16x16x32_bf16 v[68:71], v[252:255], v[176:179], v[68:71]
v_mfma_f32_16x16x32_bf16 v[72:75], v[248:251], v[180:183], v[72:75]
v_mfma_f32_16x16x32_bf16 v[76:79], v[252:255], v[180:183], v[76:79]
s_waitcnt vmcnt(0)
v_mfma_f32_16x16x32_bf16 v[64:67], v[248:251], v[184:187], v[64:67]
v_mfma_f32_16x16x32_bf16 v[68:71], v[252:255], v[184:187], v[68:71]
v_mfma_f32_16x16x32_bf16 v[72:75], v[248:251], v[188:191], v[72:75]
v_mfma_f32_16x16x32_bf16 v[76:79], v[252:255], v[188:191], v[76:79]
s_nop 7
ds_write_b128 v8, v[64:67] offset:0
ds_write_b128 v8, v[68:71] offset:1024
ds_write_b128 v8, v[72:75] offset:2048
ds_write_b128 v8, v[76:79] offset:3072
s_waitcnt lgkmcnt(0)
ds_write_b32 v13, v31 offset:21216
s_mov_b32 s61, 0
Lsp12:
ds_read_b32 v28, v14 offset:21216
s_waitcnt lgkmcnt(0)
v_readfirstlane_b32 s60, v28
s_add_u32 s61, s61, 1
s_cmp_eq_u32 s60, 1
s_cbranch_scc1 Lsx13
s_cmp_lt_u32 s61, 1048576
s_cbranch_scc1 Lsp12
Lsx13:
ds_read_b128 v[80:83], v9 offset:0
ds_read_b128 v[84:87], v9 offset:1024
ds_read_b128 v[88:91], v9 offset:2048
ds_read_b128 v[92:95], v9 offset:3072
ds_read_b128 v[96:99], v11 offset:0
ds_read_b128 v[104:107], v12 offset:0
ds_read_b128 v[100:103], v11 offset:64
ds_read_b128 v[108:111], v12 offset:64
s_waitcnt lgkmcnt(0)
v_add_f32 v64, v64, v80
v_add_f32 v65, v65, v81
v_add_f32 v66, v66, v82
v_add_f32 v67, v67, v83
v_add_f32 v68, v68, v84
v_add_f32 v69, v69, v85
v_add_f32 v70, v70, v86
v_add_f32 v71, v71, v87
v_add_f32 v72, v72, v88
v_add_f32 v73, v73, v89
v_add_f32 v74, v74, v90
v_add_f32 v75, v75, v91
v_add_f32 v76, v76, v92
v_add_f32 v77, v77, v93
v_add_f32 v78, v78, v94
v_add_f32 v79, v79, v95
v_add_f32 v96, v96, v104
v_add_f32 v97, v97, v105
v_add_f32 v98, v98, v106
v_add_f32 v99, v99, v107
v_add_f32 v100, v100, v108
v_add_f32 v101, v101, v109
v_add_f32 v102, v102, v110
v_add_f32 v103, v103, v111
v_cvt_pk_bf16_f32 v112, v64, v65
v_cvt_pk_bf16_f32 v113, v66, v67
v_cvt_pk_bf16_f32 v114, v72, v73
v_cvt_pk_bf16_f32 v115, v74, v75
v_cvt_pk_bf16_f32 v116, v68, v69
v_cvt_pk_bf16_f32 v117, v70, v71
v_cvt_pk_bf16_f32 v118, v76, v77
v_cvt_pk_bf16_f32 v119, v78, v79
v_cvt_pk_bf16_f32 v120, v96, v97
v_cvt_pk_bf16_f32 v121, v98, v99
v_cvt_pk_bf16_f32 v122, v100, v101
v_cvt_pk_bf16_f32 v123, v102, v103
s_cmp_eq_u32 s50, 0
s_cbranch_scc0 Lnsp
s_lshl_b32 s60, s96, 11
s_add_u32 s60, s60, 12124160
v_lshl_add_u32 v217, v2, 7, s60
buffer_load_dword v216, v217, s[36:39], 0 offen sc1
Lnsp:
s_nop 1
v_mfma_f32_16x16x32_bf16 v[128:131], v[112:115], v[200:203], 0
v_mfma_f32_16x16x32_bf16 v[132:135], v[116:119], v[200:203], 0
v_mfma_f32_16x16x32_bf16 v[136:139], v[120:123], v[200:203], 0
v_mfma_f32_16x16x32_bf16 v[140:143], v[112:115], v[204:207], 0
v_mfma_f32_16x16x32_bf16 v[144:147], v[116:119], v[204:207], 0
v_mfma_f32_16x16x32_bf16 v[148:151], v[120:123], v[204:207], 0
v_mfma_f32_16x16x32_bf16 v[152:155], v[112:115], v[208:211], 0
v_mfma_f32_16x16x32_bf16 v[156:159], v[116:119], v[208:211], 0
v_mfma_f32_16x16x32_bf16 v[160:163], v[120:123], v[208:211], 0
v_mfma_f32_16x16x32_bf16 v[164:167], v[112:115], v[212:215], 0
v_mfma_f32_16x16x32_bf16 v[168:171], v[116:119], v[212:215], 0
v_mfma_f32_16x16x32_bf16 v[172:175], v[120:123], v[212:215], 0
s_nop 7
v_add_f32 v136, s58, v136
v_rcp_f32 v136, v136
s_nop 0
v_mul_f32 v128, v128, v136
v_mul_f32 v129, v129, v136
v_mul_f32 v130, v130, v136
v_mul_f32 v131, v131, v136
v_cvt_pk_bf16_f32 v64, v128, v129
v_cvt_pk_bf16_f32 v65, v130, v131
v_mul_f32 v132, v132, v136
v_mul_f32 v133, v133, v136
v_mul_f32 v134, v134, v136
v_mul_f32 v135, v135, v136
v_cvt_pk_bf16_f32 v66, v132, v133
v_cvt_pk_bf16_f32 v67, v134, v135
s_nop 1
v_permlane16_swap_b32 v64, v66
v_permlane16_swap_b32 v65, v67
s_mov_b32 s60, 12582912
buffer_store_dwordx4 v[64:67], v5, s[36:39], s60 offen sc1
v_add_f32 v148, s58, v148
v_rcp_f32 v148, v148
s_nop 0
v_mul_f32 v140, v140, v148
v_mul_f32 v141, v141, v148
v_mul_f32 v142, v142, v148
v_mul_f32 v143, v143, v148
v_cvt_pk_bf16_f32 v68, v140, v141
v_cvt_pk_bf16_f32 v69, v142, v143
v_mul_f32 v144, v144, v148
v_mul_f32 v145, v145, v148
v_mul_f32 v146, v146, v148
v_mul_f32 v147, v147, v148
v_cvt_pk_bf16_f32 v70, v144, v145
v_cvt_pk_bf16_f32 v71, v146, v147
s_nop 1
v_permlane16_swap_b32 v68, v70
v_permlane16_swap_b32 v69, v71
s_mov_b32 s60, 12615680
buffer_store_dwordx4 v[68:71], v5, s[36:39], s60 offen sc1
v_add_f32 v160, s58, v160
v_rcp_f32 v160, v160
s_nop 0
v_mul_f32 v152, v152, v160
v_mul_f32 v153, v153, v160
v_mul_f32 v154, v154, v160
v_mul_f32 v155, v155, v160
v_cvt_pk_bf16_f32 v72, v152, v153
v_cvt_pk_bf16_f32 v73, v154, v155
v_mul_f32 v156, v156, v160
v_mul_f32 v157, v157, v160
v_mul_f32 v158, v158, v160
v_mul_f32 v159, v159, v160
v_cvt_pk_bf16_f32 v74, v156, v157
v_cvt_pk_bf16_f32 v75, v158, v159
s_nop 1
v_permlane16_swap_b32 v72, v74
v_permlane16_swap_b32 v73, v75
s_mov_b32 s60, 12648448
buffer_store_dwordx4 v[72:75], v5, s[36:39], s60 offen sc1
v_add_f32 v172, s58, v172
v_rcp_f32 v172, v172
s_nop 0
v_mul_f32 v164, v164, v172
v_mul_f32 v165, v165, v172
v_mul_f32 v166, v166, v172
v_mul_f32 v167, v167, v172
v_cvt_pk_bf16_f32 v76, v164, v165
v_cvt_pk_bf16_f32 v77, v166, v167
v_mul_f32 v168, v168, v172
v_mul_f32 v169, v169, v172
v_mul_f32 v170, v170, v172
v_mul_f32 v171, v171, v172
v_cvt_pk_bf16_f32 v78, v168, v169
v_cvt_pk_bf16_f32 v79, v170, v171
s_nop 1
v_permlane16_swap_b32 v76, v78
v_permlane16_swap_b32 v77, v79
s_mov_b32 s60, 12681216
buffer_store_dwordx4 v[76:79], v5, s[36:39], s60 offen sc1
s_setprio 3
s_lshl_b32 s57, s48, 4
s_add_u32 s57, s57, s49
s_lshl_b32 s57, s57, 7
s_add_u32 s57, s57, 12124160
v_mov_b32 v28, s57
s_mov_b32 s24, s18
s_mov_b32 s25, s19
s_mov_b32 s26, 2097152
s_mov_b32 s27, 0x00020000
v_mov_b32 v9, 0
v_mov_b32 v11, 1
s_mov_b32 s53, s50
v_lshrrev_b32 v96, 3, v0
v_and_b32 v97, 7, v0
v_lshrrev_b32 v98, 4, v0
s_cmp_eq_u32 s53, 3
s_cbranch_scc1 Lawo
s_lshl_b32 s60, s96, 7
v_add_u32 v99, s60, v96
v_lshlrev_b32 v99, 11, v99
v_xor_b32 v100, v98, v97
v_lshl_add_u32 v20, v100, 4, v99
v_xor_b32 v100, 4, v100
v_lshl_add_u32 v21, v100, 4, v99
s_mov_b32 s28, s36
s_mov_b32 s29, s37
s_mov_b32 s30, s38
s_mov_b32 s31, s39
s_sub_u32 s60, s53, 1
s_lshl_b32 s64, s60, 13
s_lshl_b32 s66, s60, 17
s_add_u32 s66, s66, 12582912
s_mov_b32 s65, 128
s_branch Lawd
Lawo:
v_and_b32 v100, 1, v98
v_lshlrev_b32 v100, 1, v100
v_xor_b32 v100, v100, v97
v_lshlrev_b32 v99, 11, v96
s_lshl_b32 s61, s97, 7
v_add_u32 v99, s61, v99
v_lshl_add_u32 v20, v100, 4, v99
v_xor_b32 v100, 4, v100
v_lshl_add_u32 v21, v100, 4, v99
s_mov_b32 s28, s24
s_mov_b32 s29, s25
s_mov_b32 s30, s26
s_mov_b32 s31, s27
s_mov_b32 s64, 16384
s_mov_b32 s66, 0
s_mov_b32 s65, 131072
Lawd:
v_lshrrev_b32 v99, 4, v0
s_lshl_b32 s60, s97, 6
v_add_u32 v99, s60, v99
v_lshlrev_b32 v99, 12, v99
v_and_b32 v100, 15, v0
v_lshl_add_u32 v99, v100, 4, v99
s_lshl_b32 s60, s96, 8
v_add_u32 v26, s60, v99
v_mov_b32 v27, 84992
s_lshl_b32 s60, s96, 11
s_add_u32 s60, s60, 12124160
v_and_b32 v102, 15, v0
v_lshl_add_u32 v102, v102, 7, s60
s_lshl_b32 s60, s97, 11
s_add_u32 s60, s60, 12156928
v_and_b32 v103, 15, v0
v_lshl_add_u32 v103, v103, 7, s60
s_mov_b32 s61, 0
Lsp14:
ds_read_b32 v29, v30 offset:42464
s_waitcnt lgkmcnt(0)
v_readfirstlane_b32 s60, v29
s_add_u32 s61, s61, 1
s_cmp_ge_u32 s60, 4
s_cbranch_scc1 Lsx15
s_cmp_lt_u32 s61, 1048576
s_cbranch_scc1 Lsp14
Lsx15:
s_waitcnt vmcnt(0)
s_mov_b64 exec, 1
ds_add_rtn_u32 v29, v30, v31 offset:42476
s_waitcnt lgkmcnt(0)
v_readfirstlane_b32 s60, v29
s_cmp_eq_u32 s60, 3
s_cbranch_scc0 Lcl16
buffer_store_dword v31, v28, s[36:39], 0 offen sc1
Lcl16:
s_mov_b64 exec, -1
s_cmp_eq_u32 s53, 0
s_cbranch_scc0 Lgload
s_mov_b32 s70, 0
s_mov_b32 s71, 0
v_mov_b32 v100, v216
v_cmp_eq_u32 vcc, 1, v100
s_nop 3
s_and_b32 s72, vcc_lo, 0xffff
s_andn2_b32 s62, s72, s71
Lab17:
s_cmp_eq_u32 s62, 0
s_cbranch_scc1 Lae18
s_ff1_i32_b32 s47, s62
s_lshl_b32 s60, 1, s47
s_or_b32 s71, s71, s60
s_andn2_b32 s62, s62, s60
s_add_u32 s47, s47, 1
v_mov_b32 v101, s47
s_lshl_b32 s60, s70, 2
v_add_u32 v104, s60, v27
ds_write_b32 v104, v101 offset:64
s_add_u32 s70, s70, 1
s_branch Lab17
Lae18:
s_mov_b32 s61, 0
Lsync0:
buffer_load_dword v100, v102, s[36:39], 0 offen sc1
s_mov_b32 s73, 0
Lsyncw:
ds_read_b32 v105, v9 offset:42480
s_waitcnt lgkmcnt(0)
v_readfirstlane_b32 s60, v105
s_add_u32 s73, s73, 1
s_cmp_ge_u32 s60, 4
s_cselect_b32 s60, 1, 0
s_cmp_ge_u32 s70, 4
s_cselect_b32 s62, 1, 0
s_and_b32 s60, s60, s62
s_cbranch_scc1 Lsync1
s_cmp_ge_u32 s70, 4
s_cselect_b32 s60, 12, 1
s_cmp_lt_u32 s73, s60
s_cbranch_scc1 Lsyncw
s_waitcnt vmcnt(0)
v_cmp_eq_u32 vcc, 1, v100
s_nop 3
s_and_b32 s72, vcc_lo, 0xffff
s_andn2_b32 s62, s72, s71
Lab19:
s_cmp_eq_u32 s62, 0
s_cbranch_scc1 Lae20
s_ff1_i32_b32 s47, s62
s_lshl_b32 s60, 1, s47
s_or_b32 s71, s71, s60
s_andn2_b32 s62, s62, s60
s_add_u32 s47, s47, 1
v_mov_b32 v101, s47
s_lshl_b32 s60, s70, 2
v_add_u32 v104, s60, v27
ds_write_b32 v104, v101 offset:64
s_add_u32 s70, s70, 1
s_branch Lab19
Lae20:
s_cmp_eq_u32 s70, 16
s_cbranch_scc1 Lsync1
s_add_u32 s61, s61, 1
s_cmp_lt_u32 s61, 131072
s_cbranch_scc1 Lsync0
v_mov_b32 v100, 1
v_cmp_eq_u32 vcc, 1, v100
s_nop 3
s_and_b32 s72, vcc_lo, 0xffff
s_andn2_b32 s62, s72, s71
Lab21:
s_cmp_eq_u32 s62, 0
s_cbranch_scc1 Lae22
s_ff1_i32_b32 s47, s62
s_lshl_b32 s60, 1, s47
s_or_b32 s71, s71, s60
s_andn2_b32 s62, s62, s60
s_add_u32 s47, s47, 1
v_mov_b32 v101, s47
s_lshl_b32 s60, s70, 2
v_add_u32 v104, s60, v27
ds_write_b32 v104, v101 offset:64
s_add_u32 s70, s70, 1
s_branch Lab21
Lae22:
Lsync1:
s_mov_b32 s73, 0
Len23:
s_cmp_ge_u32 s70, 4
s_cbranch_scc1 Lex24
buffer_load_dword v100, v102, s[36:39], 0 offen sc1
s_waitcnt vmcnt(0)
v_cmp_eq_u32 vcc, 1, v100
s_nop 3
s_and_b32 s72, vcc_lo, 0xffff
s_andn2_b32 s62, s72, s71
Lab25:
s_cmp_eq_u32 s62, 0
s_cbranch_scc1 Lae26
s_ff1_i32_b32 s47, s62
s_lshl_b32 s60, 1, s47
s_or_b32 s71, s71, s60
s_andn2_b32 s62, s62, s60
s_add_u32 s47, s47, 1
v_mov_b32 v101, s47
s_lshl_b32 s60, s70, 2
v_add_u32 v104, s60, v27
ds_write_b32 v104, v101 offset:64
s_add_u32 s70, s70, 1
s_branch Lab25
Lae26:
s_add_u32 s73, s73, 1
s_cmp_lt_u32 s73, 131072
s_cbranch_scc1 Len23
v_mov_b32 v100, 1
v_cmp_eq_u32 vcc, 1, v100
s_nop 3
s_and_b32 s72, vcc_lo, 0xffff
s_andn2_b32 s62, s72, s71
Lab27:
s_cmp_eq_u32 s62, 0
s_cbranch_scc1 Lae28
s_ff1_i32_b32 s47, s62
s_lshl_b32 s60, 1, s47
s_or_b32 s71, s71, s60
s_andn2_b32 s62, s62, s60
s_add_u32 s47, s47, 1
v_mov_b32 v101, s47
s_lshl_b32 s60, s70, 2
v_add_u32 v104, s60, v27
ds_write_b32 v104, v101 offset:64
s_add_u32 s70, s70, 1
s_branch Lab27
Lae28:
Lex24:
s_barrier
s_mov_b32 s73, 0
Len29:
s_cmp_ge_u32 s70, 6
s_cbranch_scc1 Lex30
buffer_load_dword v100, v102, s[36:39], 0 offen sc1
s_waitcnt vmcnt(0)
v_cmp_eq_u32 vcc, 1, v100
s_nop 3
s_and_b32 s72, vcc_lo, 0xffff
s_andn2_b32 s62, s72, s71
Lab31:
s_cmp_eq_u32 s62, 0
s_cbranch_scc1 Lae32
s_ff1_i32_b32 s47, s62
s_lshl_b32 s60, 1, s47
s_or_b32 s71, s71, s60
s_andn2_b32 s62, s62, s60
s_add_u32 s47, s47, 1
v_mov_b32 v101, s47
s_lshl_b32 s60, s70, 2
v_add_u32 v104, s60, v27
ds_write_b32 v104, v101 offset:64
s_add_u32 s70, s70, 1
s_branch Lab31
Lae32:
s_add_u32 s73, s73, 1
s_cmp_lt_u32 s73, 131072
s_cbranch_scc1 Len29
v_mov_b32 v100, 1
v_cmp_eq_u32 vcc, 1, v100
s_nop 3
s_and_b32 s72, vcc_lo, 0xffff
s_andn2_b32 s62, s72, s71
Lab33:
s_cmp_eq_u32 s62, 0
s_cbranch_scc1 Lae34
s_ff1_i32_b32 s47, s62
s_lshl_b32 s60, 1, s47
s_or_b32 s71, s71, s60
s_andn2_b32 s62, s62, s60
s_add_u32 s47, s47, 1
v_mov_b32 v101, s47
s_lshl_b32 s60, s70, 2
v_add_u32 v104, s60, v27
ds_write_b32 v104, v101 offset:64
s_add_u32 s70, s70, 1
s_branch Lab33
Lae34:
Lex30:
s_mov_b32 s73, 0
Len35:
s_cmp_ge_u32 s70, 6
s_cbranch_scc1 Lex36
buffer_load_dword v100, v102, s[36:39], 0 offen sc1
s_waitcnt vmcnt(0)
v_cmp_eq_u32 vcc, 1, v100
s_nop 3
s_and_b32 s72, vcc_lo, 0xffff
s_andn2_b32 s62, s72, s71
Lab37:
s_cmp_eq_u32 s62, 0
s_cbranch_scc1 Lae38
s_ff1_i32_b32 s47, s62
s_lshl_b32 s60, 1, s47
s_or_b32 s71, s71, s60
s_andn2_b32 s62, s62, s60
s_add_u32 s47, s47, 1
v_mov_b32 v101, s47
s_lshl_b32 s60, s70, 2
v_add_u32 v104, s60, v27
ds_write_b32 v104, v101 offset:64
s_add_u32 s70, s70, 1
s_branch Lab37
Lae38:
s_add_u32 s73, s73, 1
s_cmp_lt_u32 s73, 131072
s_cbranch_scc1 Len35
v_mov_b32 v100, 1
v_cmp_eq_u32 vcc, 1, v100
s_nop 3
s_and_b32 s72, vcc_lo, 0xffff
s_andn2_b32 s62, s72, s71
Lab39:
s_cmp_eq_u32 s62, 0
s_cbranch_scc1 Lae40
s_ff1_i32_b32 s47, s62
s_lshl_b32 s60, 1, s47
s_or_b32 s71, s71, s60
s_andn2_b32 s62, s62, s60
s_add_u32 s47, s47, 1
v_mov_b32 v101, s47
s_lshl_b32 s60, s70, 2
v_add_u32 v104, s60, v27
ds_write_b32 v104, v101 offset:64
s_add_u32 s70, s70, 1
s_branch Lab39
Lae40:
Lex36:
s_barrier
s_mov_b32 s73, 0
Len41:
s_cmp_ge_u32 s70, 8
s_cbranch_scc1 Lex42
buffer_load_dword v100, v102, s[36:39], 0 offen sc1
s_waitcnt vmcnt(0)
v_cmp_eq_u32 vcc, 1, v100
s_nop 3
s_and_b32 s72, vcc_lo, 0xffff
s_andn2_b32 s62, s72, s71
Lab43:
s_cmp_eq_u32 s62, 0
s_cbranch_scc1 Lae44
s_ff1_i32_b32 s47, s62
s_lshl_b32 s60, 1, s47
s_or_b32 s71, s71, s60
s_andn2_b32 s62, s62, s60
s_add_u32 s47, s47, 1
v_mov_b32 v101, s47
s_lshl_b32 s60, s70, 2
v_add_u32 v104, s60, v27
ds_write_b32 v104, v101 offset:64
s_add_u32 s70, s70, 1
s_branch Lab43
Lae44:
s_add_u32 s73, s73, 1
s_cmp_lt_u32 s73, 131072
s_cbranch_scc1 Len41
v_mov_b32 v100, 1
v_cmp_eq_u32 vcc, 1, v100
s_nop 3
s_and_b32 s72, vcc_lo, 0xffff
s_andn2_b32 s62, s72, s71
Lab45:
s_cmp_eq_u32 s62, 0
s_cbranch_scc1 Lae46
s_ff1_i32_b32 s47, s62
s_lshl_b32 s60, 1, s47
s_or_b32 s71, s71, s60
s_andn2_b32 s62, s62, s60
s_add_u32 s47, s47, 1
v_mov_b32 v101, s47
s_lshl_b32 s60, s70, 2
v_add_u32 v104, s60, v27
ds_write_b32 v104, v101 offset:64
s_add_u32 s70, s70, 1
s_branch Lab45
Lae46:
Lex42:
s_mov_b32 s73, 0
Len47:
s_cmp_ge_u32 s70, 8
s_cbranch_scc1 Lex48
buffer_load_dword v100, v102, s[36:39], 0 offen sc1
s_waitcnt vmcnt(0)
v_cmp_eq_u32 vcc, 1, v100
s_nop 3
s_and_b32 s72, vcc_lo, 0xffff
s_andn2_b32 s62, s72, s71
Lab49:
s_cmp_eq_u32 s62, 0
s_cbranch_scc1 Lae50
s_ff1_i32_b32 s47, s62
s_lshl_b32 s60, 1, s47
s_or_b32 s71, s71, s60
s_andn2_b32 s62, s62, s60
s_add_u32 s47, s47, 1
v_mov_b32 v101, s47
s_lshl_b32 s60, s70, 2
v_add_u32 v104, s60, v27
ds_write_b32 v104, v101 offset:64
s_add_u32 s70, s70, 1
s_branch Lab49
Lae50:
s_add_u32 s73, s73, 1
s_cmp_lt_u32 s73, 131072
s_cbranch_scc1 Len47
v_mov_b32 v100, 1
v_cmp_eq_u32 vcc, 1, v100
s_nop 3
s_and_b32 s72, vcc_lo, 0xffff
s_andn2_b32 s62, s72, s71
Lab51:
s_cmp_eq_u32 s62, 0
s_cbranch_scc1 Lae52
s_ff1_i32_b32 s47, s62
s_lshl_b32 s60, 1, s47
s_or_b32 s71, s71, s60
s_andn2_b32 s62, s62, s60
s_add_u32 s47, s47, 1
v_mov_b32 v101, s47
s_lshl_b32 s60, s70, 2
v_add_u32 v104, s60, v27
ds_write_b32 v104, v101 offset:64
s_add_u32 s70, s70, 1
s_branch Lab51
Lae52:
Lex48:
s_barrier
s_mov_b32 s73, 0
Len53:
s_cmp_ge_u32 s70, 9
s_cbranch_scc1 Lex54
buffer_load_dword v100, v102, s[36:39], 0 offen sc1
s_waitcnt vmcnt(0)
v_cmp_eq_u32 vcc, 1, v100
s_nop 3
s_and_b32 s72, vcc_lo, 0xffff
s_andn2_b32 s62, s72, s71
Lab55:
s_cmp_eq_u32 s62, 0
s_cbranch_scc1 Lae56
s_ff1_i32_b32 s47, s62
s_lshl_b32 s60, 1, s47
s_or_b32 s71, s71, s60
s_andn2_b32 s62, s62, s60
s_add_u32 s47, s47, 1
v_mov_b32 v101, s47
s_lshl_b32 s60, s70, 2
v_add_u32 v104, s60, v27
ds_write_b32 v104, v101 offset:64
s_add_u32 s70, s70, 1
s_branch Lab55
Lae56:
s_add_u32 s73, s73, 1
s_cmp_lt_u32 s73, 131072
s_cbranch_scc1 Len53
v_mov_b32 v100, 1
v_cmp_eq_u32 vcc, 1, v100
s_nop 3
s_and_b32 s72, vcc_lo, 0xffff
s_andn2_b32 s62, s72, s71
Lab57:
s_cmp_eq_u32 s62, 0
s_cbranch_scc1 Lae58
s_ff1_i32_b32 s47, s62
s_lshl_b32 s60, 1, s47
s_or_b32 s71, s71, s60
s_andn2_b32 s62, s62, s60
s_add_u32 s47, s47, 1
v_mov_b32 v101, s47
s_lshl_b32 s60, s70, 2
v_add_u32 v104, s60, v27
ds_write_b32 v104, v101 offset:64
s_add_u32 s70, s70, 1
s_branch Lab57
Lae58:
Lex54:
s_mov_b32 s73, 0
Len59:
s_cmp_ge_u32 s70, 9
s_cbranch_scc1 Lex60
buffer_load_dword v100, v102, s[36:39], 0 offen sc1
s_waitcnt vmcnt(0)
v_cmp_eq_u32 vcc, 1, v100
s_nop 3
s_and_b32 s72, vcc_lo, 0xffff
s_andn2_b32 s62, s72, s71
Lab61:
s_cmp_eq_u32 s62, 0
s_cbranch_scc1 Lae62
s_ff1_i32_b32 s47, s62
s_lshl_b32 s60, 1, s47
s_or_b32 s71, s71, s60
s_andn2_b32 s62, s62, s60
s_add_u32 s47, s47, 1
v_mov_b32 v101, s47
s_lshl_b32 s60, s70, 2
v_add_u32 v104, s60, v27
ds_write_b32 v104, v101 offset:64
s_add_u32 s70, s70, 1
s_branch Lab61
Lae62:
s_add_u32 s73, s73, 1
s_cmp_lt_u32 s73, 131072
s_cbranch_scc1 Len59
v_mov_b32 v100, 1
v_cmp_eq_u32 vcc, 1, v100
s_nop 3
s_and_b32 s72, vcc_lo, 0xffff
s_andn2_b32 s62, s72, s71
Lab63:
s_cmp_eq_u32 s62, 0
s_cbranch_scc1 Lae64
s_ff1_i32_b32 s47, s62
s_lshl_b32 s60, 1, s47
s_or_b32 s71, s71, s60
s_andn2_b32 s62, s62, s60
s_add_u32 s47, s47, 1
v_mov_b32 v101, s47
s_lshl_b32 s60, s70, 2
v_add_u32 v104, s60, v27
ds_write_b32 v104, v101 offset:64
s_add_u32 s70, s70, 1
s_branch Lab63
Lae64:
Lex60:
s_barrier
s_mov_b32 s73, 0
Len65:
s_cmp_ge_u32 s70, 10
s_cbranch_scc1 Lex66
buffer_load_dword v100, v102, s[36:39], 0 offen sc1
s_waitcnt vmcnt(0)
v_cmp_eq_u32 vcc, 1, v100
s_nop 3
s_and_b32 s72, vcc_lo, 0xffff
s_andn2_b32 s62, s72, s71
Lab67:
s_cmp_eq_u32 s62, 0
s_cbranch_scc1 Lae68
s_ff1_i32_b32 s47, s62
s_lshl_b32 s60, 1, s47
s_or_b32 s71, s71, s60
s_andn2_b32 s62, s62, s60
s_add_u32 s47, s47, 1
v_mov_b32 v101, s47
s_lshl_b32 s60, s70, 2
v_add_u32 v104, s60, v27
ds_write_b32 v104, v101 offset:64
s_add_u32 s70, s70, 1
s_branch Lab67
Lae68:
s_add_u32 s73, s73, 1
s_cmp_lt_u32 s73, 131072
s_cbranch_scc1 Len65
v_mov_b32 v100, 1
v_cmp_eq_u32 vcc, 1, v100
s_nop 3
s_and_b32 s72, vcc_lo, 0xffff
s_andn2_b32 s62, s72, s71
Lab69:
s_cmp_eq_u32 s62, 0
s_cbranch_scc1 Lae70
s_ff1_i32_b32 s47, s62
s_lshl_b32 s60, 1, s47
s_or_b32 s71, s71, s60
s_andn2_b32 s62, s62, s60
s_add_u32 s47, s47, 1
v_mov_b32 v101, s47
s_lshl_b32 s60, s70, 2
v_add_u32 v104, s60, v27
ds_write_b32 v104, v101 offset:64
s_add_u32 s70, s70, 1
s_branch Lab69
Lae70:
Lex66:
s_mov_b32 s73, 0
Len71:
s_cmp_ge_u32 s70, 10
s_cbranch_scc1 Lex72
buffer_load_dword v100, v102, s[36:39], 0 offen sc1
s_waitcnt vmcnt(0)
v_cmp_eq_u32 vcc, 1, v100
s_nop 3
s_and_b32 s72, vcc_lo, 0xffff
s_andn2_b32 s62, s72, s71
Lab73:
s_cmp_eq_u32 s62, 0
s_cbranch_scc1 Lae74
s_ff1_i32_b32 s47, s62
s_lshl_b32 s60, 1, s47
s_or_b32 s71, s71, s60
s_andn2_b32 s62, s62, s60
s_add_u32 s47, s47, 1
v_mov_b32 v101, s47
s_lshl_b32 s60, s70, 2
v_add_u32 v104, s60, v27
ds_write_b32 v104, v101 offset:64
s_add_u32 s70, s70, 1
s_branch Lab73
Lae74:
s_add_u32 s73, s73, 1
s_cmp_lt_u32 s73, 131072
s_cbranch_scc1 Len71
v_mov_b32 v100, 1
v_cmp_eq_u32 vcc, 1, v100
s_nop 3
s_and_b32 s72, vcc_lo, 0xffff
s_andn2_b32 s62, s72, s71
Lab75:
s_cmp_eq_u32 s62, 0
s_cbranch_scc1 Lae76
s_ff1_i32_b32 s47, s62
s_lshl_b32 s60, 1, s47
s_or_b32 s71, s71, s60
s_andn2_b32 s62, s62, s60
s_add_u32 s47, s47, 1
v_mov_b32 v101, s47
s_lshl_b32 s60, s70, 2
v_add_u32 v104, s60, v27
ds_write_b32 v104, v101 offset:64
s_add_u32 s70, s70, 1
s_branch Lab75
Lae76:
Lex72:
s_barrier
s_mov_b32 s73, 0
Len77:
s_cmp_ge_u32 s70, 11
s_cbranch_scc1 Lex78
buffer_load_dword v100, v102, s[36:39], 0 offen sc1
s_waitcnt vmcnt(0)
v_cmp_eq_u32 vcc, 1, v100
s_nop 3
s_and_b32 s72, vcc_lo, 0xffff
s_andn2_b32 s62, s72, s71
Lab79:
s_cmp_eq_u32 s62, 0
s_cbranch_scc1 Lae80
s_ff1_i32_b32 s47, s62
s_lshl_b32 s60, 1, s47
s_or_b32 s71, s71, s60
s_andn2_b32 s62, s62, s60
s_add_u32 s47, s47, 1
v_mov_b32 v101, s47
s_lshl_b32 s60, s70, 2
v_add_u32 v104, s60, v27
ds_write_b32 v104, v101 offset:64
s_add_u32 s70, s70, 1
s_branch Lab79
Lae80:
s_add_u32 s73, s73, 1
s_cmp_lt_u32 s73, 131072
s_cbranch_scc1 Len77
v_mov_b32 v100, 1
v_cmp_eq_u32 vcc, 1, v100
s_nop 3
s_and_b32 s72, vcc_lo, 0xffff
s_andn2_b32 s62, s72, s71
Lab81:
s_cmp_eq_u32 s62, 0
s_cbranch_scc1 Lae82
s_ff1_i32_b32 s47, s62
s_lshl_b32 s60, 1, s47
s_or_b32 s71, s71, s60
s_andn2_b32 s62, s62, s60
s_add_u32 s47, s47, 1
v_mov_b32 v101, s47
s_lshl_b32 s60, s70, 2
v_add_u32 v104, s60, v27
ds_write_b32 v104, v101 offset:64
s_add_u32 s70, s70, 1
s_branch Lab81
Lae82:
Lex78:
s_mov_b32 s73, 0
Len83:
s_cmp_ge_u32 s70, 11
s_cbranch_scc1 Lex84
buffer_load_dword v100, v102, s[36:39], 0 offen sc1
s_waitcnt vmcnt(0)
v_cmp_eq_u32 vcc, 1, v100
s_nop 3
s_and_b32 s72, vcc_lo, 0xffff
s_andn2_b32 s62, s72, s71
Lab85:
s_cmp_eq_u32 s62, 0
s_cbranch_scc1 Lae86
s_ff1_i32_b32 s47, s62
s_lshl_b32 s60, 1, s47
s_or_b32 s71, s71, s60
s_andn2_b32 s62, s62, s60
s_add_u32 s47, s47, 1
v_mov_b32 v101, s47
s_lshl_b32 s60, s70, 2
v_add_u32 v104, s60, v27
ds_write_b32 v104, v101 offset:64
s_add_u32 s70, s70, 1
s_branch Lab85
Lae86:
s_add_u32 s73, s73, 1
s_cmp_lt_u32 s73, 131072
s_cbranch_scc1 Len83
v_mov_b32 v100, 1
v_cmp_eq_u32 vcc, 1, v100
s_nop 3
s_and_b32 s72, vcc_lo, 0xffff
s_andn2_b32 s62, s72, s71
Lab87:
s_cmp_eq_u32 s62, 0
s_cbranch_scc1 Lae88
s_ff1_i32_b32 s47, s62
s_lshl_b32 s60, 1, s47
s_or_b32 s71, s71, s60
s_andn2_b32 s62, s62, s60
s_add_u32 s47, s47, 1
v_mov_b32 v101, s47
s_lshl_b32 s60, s70, 2
v_add_u32 v104, s60, v27
ds_write_b32 v104, v101 offset:64
s_add_u32 s70, s70, 1
s_branch Lab87
Lae88:
Lex84:
s_barrier
s_mov_b32 s73, 0
Len89:
s_cmp_ge_u32 s70, 12
s_cbranch_scc1 Lex90
buffer_load_dword v100, v102, s[36:39], 0 offen sc1
s_waitcnt vmcnt(0)
v_cmp_eq_u32 vcc, 1, v100
s_nop 3
s_and_b32 s72, vcc_lo, 0xffff
s_andn2_b32 s62, s72, s71
Lab91:
s_cmp_eq_u32 s62, 0
s_cbranch_scc1 Lae92
s_ff1_i32_b32 s47, s62
s_lshl_b32 s60, 1, s47
s_or_b32 s71, s71, s60
s_andn2_b32 s62, s62, s60
s_add_u32 s47, s47, 1
v_mov_b32 v101, s47
s_lshl_b32 s60, s70, 2
v_add_u32 v104, s60, v27
ds_write_b32 v104, v101 offset:64
s_add_u32 s70, s70, 1
s_branch Lab91
Lae92:
s_add_u32 s73, s73, 1
s_cmp_lt_u32 s73, 131072
s_cbranch_scc1 Len89
v_mov_b32 v100, 1
v_cmp_eq_u32 vcc, 1, v100
s_nop 3
s_and_b32 s72, vcc_lo, 0xffff
s_andn2_b32 s62, s72, s71
Lab93:
s_cmp_eq_u32 s62, 0
s_cbranch_scc1 Lae94
s_ff1_i32_b32 s47, s62
s_lshl_b32 s60, 1, s47
s_or_b32 s71, s71, s60
s_andn2_b32 s62, s62, s60
s_add_u32 s47, s47, 1
v_mov_b32 v101, s47
s_lshl_b32 s60, s70, 2
v_add_u32 v104, s60, v27
ds_write_b32 v104, v101 offset:64
s_add_u32 s70, s70, 1
s_branch Lab93
Lae94:
Lex90:
s_mov_b32 s73, 0
Len95:
s_cmp_ge_u32 s70, 12
s_cbranch_scc1 Lex96
buffer_load_dword v100, v102, s[36:39], 0 offen sc1
s_waitcnt vmcnt(0)
v_cmp_eq_u32 vcc, 1, v100
s_nop 3
s_and_b32 s72, vcc_lo, 0xffff
s_andn2_b32 s62, s72, s71
Lab97:
s_cmp_eq_u32 s62, 0
s_cbranch_scc1 Lae98
s_ff1_i32_b32 s47, s62
s_lshl_b32 s60, 1, s47
s_or_b32 s71, s71, s60
s_andn2_b32 s62, s62, s60
s_add_u32 s47, s47, 1
v_mov_b32 v101, s47
s_lshl_b32 s60, s70, 2
v_add_u32 v104, s60, v27
ds_write_b32 v104, v101 offset:64
s_add_u32 s70, s70, 1
s_branch Lab97
Lae98:
s_add_u32 s73, s73, 1
s_cmp_lt_u32 s73, 131072
s_cbranch_scc1 Len95
v_mov_b32 v100, 1
v_cmp_eq_u32 vcc, 1, v100
s_nop 3
s_and_b32 s72, vcc_lo, 0xffff
s_andn2_b32 s62, s72, s71
Lab99:
s_cmp_eq_u32 s62, 0
s_cbranch_scc1 Lae100
s_ff1_i32_b32 s47, s62
s_lshl_b32 s60, 1, s47
s_or_b32 s71, s71, s60
s_andn2_b32 s62, s62, s60
s_add_u32 s47, s47, 1
v_mov_b32 v101, s47
s_lshl_b32 s60, s70, 2
v_add_u32 v104, s60, v27
ds_write_b32 v104, v101 offset:64
s_add_u32 s70, s70, 1
s_branch Lab99
Lae100:
Lex96:
s_barrier
s_mov_b32 s73, 0
Len101:
s_cmp_ge_u32 s70, 13
s_cbranch_scc1 Lex102
buffer_load_dword v100, v102, s[36:39], 0 offen sc1
s_waitcnt vmcnt(0)
v_cmp_eq_u32 vcc, 1, v100
s_nop 3
s_and_b32 s72, vcc_lo, 0xffff
s_andn2_b32 s62, s72, s71
Lab103:
s_cmp_eq_u32 s62, 0
s_cbranch_scc1 Lae104
s_ff1_i32_b32 s47, s62
s_lshl_b32 s60, 1, s47
s_or_b32 s71, s71, s60
s_andn2_b32 s62, s62, s60
s_add_u32 s47, s47, 1
v_mov_b32 v101, s47
s_lshl_b32 s60, s70, 2
v_add_u32 v104, s60, v27
ds_write_b32 v104, v101 offset:64
s_add_u32 s70, s70, 1
s_branch Lab103
Lae104:
s_add_u32 s73, s73, 1
s_cmp_lt_u32 s73, 131072
s_cbranch_scc1 Len101
v_mov_b32 v100, 1
v_cmp_eq_u32 vcc, 1, v100
s_nop 3
s_and_b32 s72, vcc_lo, 0xffff
s_andn2_b32 s62, s72, s71
Lab105:
s_cmp_eq_u32 s62, 0
s_cbranch_scc1 Lae106
s_ff1_i32_b32 s47, s62
s_lshl_b32 s60, 1, s47
s_or_b32 s71, s71, s60
s_andn2_b32 s62, s62, s60
s_add_u32 s47, s47, 1
v_mov_b32 v101, s47
s_lshl_b32 s60, s70, 2
v_add_u32 v104, s60, v27
ds_write_b32 v104, v101 offset:64
s_add_u32 s70, s70, 1
s_branch Lab105
Lae106:
Lex102:
s_mov_b32 s73, 0
Len107:
s_cmp_ge_u32 s70, 13
s_cbranch_scc1 Lex108
buffer_load_dword v100, v102, s[36:39], 0 offen sc1
s_waitcnt vmcnt(0)
v_cmp_eq_u32 vcc, 1, v100
s_nop 3
s_and_b32 s72, vcc_lo, 0xffff
s_andn2_b32 s62, s72, s71
Lab109:
s_cmp_eq_u32 s62, 0
s_cbranch_scc1 Lae110
s_ff1_i32_b32 s47, s62
s_lshl_b32 s60, 1, s47
s_or_b32 s71, s71, s60
s_andn2_b32 s62, s62, s60
s_add_u32 s47, s47, 1
v_mov_b32 v101, s47
s_lshl_b32 s60, s70, 2
v_add_u32 v104, s60, v27
ds_write_b32 v104, v101 offset:64
s_add_u32 s70, s70, 1
s_branch Lab109
Lae110:
s_add_u32 s73, s73, 1
s_cmp_lt_u32 s73, 131072
s_cbranch_scc1 Len107
v_mov_b32 v100, 1
v_cmp_eq_u32 vcc, 1, v100
s_nop 3
s_and_b32 s72, vcc_lo, 0xffff
s_andn2_b32 s62, s72, s71
Lab111:
s_cmp_eq_u32 s62, 0
s_cbranch_scc1 Lae112
s_ff1_i32_b32 s47, s62
s_lshl_b32 s60, 1, s47
s_or_b32 s71, s71, s60
s_andn2_b32 s62, s62, s60
s_add_u32 s47, s47, 1
v_mov_b32 v101, s47
s_lshl_b32 s60, s70, 2
v_add_u32 v104, s60, v27
ds_write_b32 v104, v101 offset:64
s_add_u32 s70, s70, 1
s_branch Lab111
Lae112:
Lex108:
s_barrier
s_mov_b32 s73, 0
Len113:
s_cmp_ge_u32 s70, 14
s_cbranch_scc1 Lex114
buffer_load_dword v100, v102, s[36:39], 0 offen sc1
s_waitcnt vmcnt(0)
v_cmp_eq_u32 vcc, 1, v100
s_nop 3
s_and_b32 s72, vcc_lo, 0xffff
s_andn2_b32 s62, s72, s71
Lab115:
s_cmp_eq_u32 s62, 0
s_cbranch_scc1 Lae116
s_ff1_i32_b32 s47, s62
s_lshl_b32 s60, 1, s47
s_or_b32 s71, s71, s60
s_andn2_b32 s62, s62, s60
s_add_u32 s47, s47, 1
v_mov_b32 v101, s47
s_lshl_b32 s60, s70, 2
v_add_u32 v104, s60, v27
ds_write_b32 v104, v101 offset:64
s_add_u32 s70, s70, 1
s_branch Lab115
Lae116:
s_add_u32 s73, s73, 1
s_cmp_lt_u32 s73, 131072
s_cbranch_scc1 Len113
v_mov_b32 v100, 1
v_cmp_eq_u32 vcc, 1, v100
s_nop 3
s_and_b32 s72, vcc_lo, 0xffff
s_andn2_b32 s62, s72, s71
Lab117:
s_cmp_eq_u32 s62, 0
s_cbranch_scc1 Lae118
s_ff1_i32_b32 s47, s62
s_lshl_b32 s60, 1, s47
s_or_b32 s71, s71, s60
s_andn2_b32 s62, s62, s60
s_add_u32 s47, s47, 1
v_mov_b32 v101, s47
s_lshl_b32 s60, s70, 2
v_add_u32 v104, s60, v27
ds_write_b32 v104, v101 offset:64
s_add_u32 s70, s70, 1
s_branch Lab117
Lae118:
Lex114:
s_mov_b32 s73, 0
Len119:
s_cmp_ge_u32 s70, 14
s_cbranch_scc1 Lex120
buffer_load_dword v100, v102, s[36:39], 0 offen sc1
s_waitcnt vmcnt(0)
v_cmp_eq_u32 vcc, 1, v100
s_nop 3
s_and_b32 s72, vcc_lo, 0xffff
s_andn2_b32 s62, s72, s71
Lab121:
s_cmp_eq_u32 s62, 0
s_cbranch_scc1 Lae122
s_ff1_i32_b32 s47, s62
s_lshl_b32 s60, 1, s47
s_or_b32 s71, s71, s60
s_andn2_b32 s62, s62, s60
s_add_u32 s47, s47, 1
v_mov_b32 v101, s47
s_lshl_b32 s60, s70, 2
v_add_u32 v104, s60, v27
ds_write_b32 v104, v101 offset:64
s_add_u32 s70, s70, 1
s_branch Lab121
Lae122:
s_add_u32 s73, s73, 1
s_cmp_lt_u32 s73, 131072
s_cbranch_scc1 Len119
v_mov_b32 v100, 1
v_cmp_eq_u32 vcc, 1, v100
s_nop 3
s_and_b32 s72, vcc_lo, 0xffff
s_andn2_b32 s62, s72, s71
Lab123:
s_cmp_eq_u32 s62, 0
s_cbranch_scc1 Lae124
s_ff1_i32_b32 s47, s62
s_lshl_b32 s60, 1, s47
s_or_b32 s71, s71, s60
s_andn2_b32 s62, s62, s60
s_add_u32 s47, s47, 1
v_mov_b32 v101, s47
s_lshl_b32 s60, s70, 2
v_add_u32 v104, s60, v27
ds_write_b32 v104, v101 offset:64
s_add_u32 s70, s70, 1
s_branch Lab123
Lae124:
Lex120:
s_barrier
s_mov_b32 s73, 0
Len125:
s_cmp_ge_u32 s70, 15
s_cbranch_scc1 Lex126
buffer_load_dword v100, v102, s[36:39], 0 offen sc1
s_waitcnt vmcnt(0)
v_cmp_eq_u32 vcc, 1, v100
s_nop 3
s_and_b32 s72, vcc_lo, 0xffff
s_andn2_b32 s62, s72, s71
Lab127:
s_cmp_eq_u32 s62, 0
s_cbranch_scc1 Lae128
s_ff1_i32_b32 s47, s62
s_lshl_b32 s60, 1, s47
s_or_b32 s71, s71, s60
s_andn2_b32 s62, s62, s60
s_add_u32 s47, s47, 1
v_mov_b32 v101, s47
s_lshl_b32 s60, s70, 2
v_add_u32 v104, s60, v27
ds_write_b32 v104, v101 offset:64
s_add_u32 s70, s70, 1
s_branch Lab127
Lae128:
s_add_u32 s73, s73, 1
s_cmp_lt_u32 s73, 131072
s_cbranch_scc1 Len125
v_mov_b32 v100, 1
v_cmp_eq_u32 vcc, 1, v100
s_nop 3
s_and_b32 s72, vcc_lo, 0xffff
s_andn2_b32 s62, s72, s71
Lab129:
s_cmp_eq_u32 s62, 0
s_cbranch_scc1 Lae130
s_ff1_i32_b32 s47, s62
s_lshl_b32 s60, 1, s47
s_or_b32 s71, s71, s60
s_andn2_b32 s62, s62, s60
s_add_u32 s47, s47, 1
v_mov_b32 v101, s47
s_lshl_b32 s60, s70, 2
v_add_u32 v104, s60, v27
ds_write_b32 v104, v101 offset:64
s_add_u32 s70, s70, 1
s_branch Lab129
Lae130:
Lex126:
s_mov_b32 s73, 0
Len131:
s_cmp_ge_u32 s70, 15
s_cbranch_scc1 Lex132
buffer_load_dword v100, v102, s[36:39], 0 offen sc1
s_waitcnt vmcnt(0)
v_cmp_eq_u32 vcc, 1, v100
s_nop 3
s_and_b32 s72, vcc_lo, 0xffff
s_andn2_b32 s62, s72, s71
Lab133:
s_cmp_eq_u32 s62, 0
s_cbranch_scc1 Lae134
s_ff1_i32_b32 s47, s62
s_lshl_b32 s60, 1, s47
s_or_b32 s71, s71, s60
s_andn2_b32 s62, s62, s60
s_add_u32 s47, s47, 1
v_mov_b32 v101, s47
s_lshl_b32 s60, s70, 2
v_add_u32 v104, s60, v27
ds_write_b32 v104, v101 offset:64
s_add_u32 s70, s70, 1
s_branch Lab133
Lae134:
s_add_u32 s73, s73, 1
s_cmp_lt_u32 s73, 131072
s_cbranch_scc1 Len131
v_mov_b32 v100, 1
v_cmp_eq_u32 vcc, 1, v100
s_nop 3
s_and_b32 s72, vcc_lo, 0xffff
s_andn2_b32 s62, s72, s71
Lab135:
s_cmp_eq_u32 s62, 0
s_cbranch_scc1 Lae136
s_ff1_i32_b32 s47, s62
s_lshl_b32 s60, 1, s47
s_or_b32 s71, s71, s60
s_andn2_b32 s62, s62, s60
s_add_u32 s47, s47, 1
v_mov_b32 v101, s47
s_lshl_b32 s60, s70, 2
v_add_u32 v104, s60, v27
ds_write_b32 v104, v101 offset:64
s_add_u32 s70, s70, 1
s_branch Lab135
Lae136:
Lex132:
s_barrier
s_mov_b32 s73, 0
Len137:
s_cmp_ge_u32 s70, 16
s_cbranch_scc1 Lex138
buffer_load_dword v100, v102, s[36:39], 0 offen sc1
s_waitcnt vmcnt(0)
v_cmp_eq_u32 vcc, 1, v100
s_nop 3
s_and_b32 s72, vcc_lo, 0xffff
s_andn2_b32 s62, s72, s71
Lab139:
s_cmp_eq_u32 s62, 0
s_cbranch_scc1 Lae140
s_ff1_i32_b32 s47, s62
s_lshl_b32 s60, 1, s47
s_or_b32 s71, s71, s60
s_andn2_b32 s62, s62, s60
s_add_u32 s47, s47, 1
v_mov_b32 v101, s47
s_lshl_b32 s60, s70, 2
v_add_u32 v104, s60, v27
ds_write_b32 v104, v101 offset:64
s_add_u32 s70, s70, 1
s_branch Lab139
Lae140:
s_add_u32 s73, s73, 1
s_cmp_lt_u32 s73, 131072
s_cbranch_scc1 Len137
v_mov_b32 v100, 1
v_cmp_eq_u32 vcc, 1, v100
s_nop 3
s_and_b32 s72, vcc_lo, 0xffff
s_andn2_b32 s62, s72, s71
Lab141:
s_cmp_eq_u32 s62, 0
s_cbranch_scc1 Lae142
s_ff1_i32_b32 s47, s62
s_lshl_b32 s60, 1, s47
s_or_b32 s71, s71, s60
s_andn2_b32 s62, s62, s60
s_add_u32 s47, s47, 1
v_mov_b32 v101, s47
s_lshl_b32 s60, s70, 2
v_add_u32 v104, s60, v27
ds_write_b32 v104, v101 offset:64
s_add_u32 s70, s70, 1
s_branch Lab141
Lae142:
Lex138:
buffer_load_dword v106, v103, s[36:39], 0 offen sc1
s_mov_b32 s73, 0
Len143:
s_cmp_ge_u32 s70, 16
s_cbranch_scc1 Lex144
buffer_load_dword v100, v102, s[36:39], 0 offen sc1
s_waitcnt vmcnt(0)
v_cmp_eq_u32 vcc, 1, v100
s_nop 3
s_and_b32 s72, vcc_lo, 0xffff
s_andn2_b32 s62, s72, s71
Lab145:
s_cmp_eq_u32 s62, 0
s_cbranch_scc1 Lae146
s_ff1_i32_b32 s47, s62
s_lshl_b32 s60, 1, s47
s_or_b32 s71, s71, s60
s_andn2_b32 s62, s62, s60
s_add_u32 s47, s47, 1
v_mov_b32 v101, s47
s_lshl_b32 s60, s70, 2
v_add_u32 v104, s60, v27
ds_write_b32 v104, v101 offset:64
s_add_u32 s70, s70, 1
s_branch Lab145
Lae146:
s_add_u32 s73, s73, 1
s_cmp_lt_u32 s73, 131072
s_cbranch_scc1 Len143
v_mov_b32 v100, 1
v_cmp_eq_u32 vcc, 1, v100
s_nop 3
s_and_b32 s72, vcc_lo, 0xffff
s_andn2_b32 s62, s72, s71
Lab147:
s_cmp_eq_u32 s62, 0
s_cbranch_scc1 Lae148
s_ff1_i32_b32 s47, s62
s_lshl_b32 s60, 1, s47
s_or_b32 s71, s71, s60
s_andn2_b32 s62, s62, s60
s_add_u32 s47, s47, 1
v_mov_b32 v101, s47
s_lshl_b32 s60, s70, 2
v_add_u32 v104, s60, v27
ds_write_b32 v104, v101 offset:64
s_add_u32 s70, s70, 1
s_branch Lab147
Lae148:
Lex144:
s_barrier
s_mov_b32 s73, 0
Len149:
s_cmp_ge_u32 s70, 16
s_cbranch_scc1 Lex150
buffer_load_dword v100, v102, s[36:39], 0 offen sc1
s_waitcnt vmcnt(0)
v_cmp_eq_u32 vcc, 1, v100
s_nop 3
s_and_b32 s72, vcc_lo, 0xffff
s_andn2_b32 s62, s72, s71
Lab151:
s_cmp_eq_u32 s62, 0
s_cbranch_scc1 Lae152
s_ff1_i32_b32 s47, s62
s_lshl_b32 s60, 1, s47
s_or_b32 s71, s71, s60
s_andn2_b32 s62, s62, s60
s_add_u32 s47, s47, 1
v_mov_b32 v101, s47
s_lshl_b32 s60, s70, 2
v_add_u32 v104, s60, v27
ds_write_b32 v104, v101 offset:64
s_add_u32 s70, s70, 1
s_branch Lab151
Lae152:
s_add_u32 s73, s73, 1
s_cmp_lt_u32 s73, 131072
s_cbranch_scc1 Len149
v_mov_b32 v100, 1
v_cmp_eq_u32 vcc, 1, v100
s_nop 3
s_and_b32 s72, vcc_lo, 0xffff
s_andn2_b32 s62, s72, s71
Lab153:
s_cmp_eq_u32 s62, 0
s_cbranch_scc1 Lae154
s_ff1_i32_b32 s47, s62
s_lshl_b32 s60, 1, s47
s_or_b32 s71, s71, s60
s_andn2_b32 s62, s62, s60
s_add_u32 s47, s47, 1
v_mov_b32 v101, s47
s_lshl_b32 s60, s70, 2
v_add_u32 v104, s60, v27
ds_write_b32 v104, v101 offset:64
s_add_u32 s70, s70, 1
s_branch Lab153
Lae154:
Lex150:
s_barrier
s_mov_b32 s73, 0
Lsz156:
s_waitcnt vmcnt(0)
v_cmp_ne_u32 vcc, 1, v106
s_add_u32 s73, s73, 1
s_nop 3
s_cmp_eq_u64 vcc, 0
s_cbranch_scc1 Lsy155
buffer_load_dword v106, v103, s[36:39], 0 offen sc1
s_cmp_lt_u32 s73, 131072
s_cbranch_scc1 Lsz156
Lsy155:
s_mov_b32 m0, 24576
s_mov_b32 s61, 16777216
buffer_load_dwordx4 v26, s[36:39], s61 offen sc1 lds
s_mov_b32 m0, 25600
s_mov_b32 s61, 16793600
buffer_load_dwordx4 v26, s[36:39], s61 offen sc1 lds
s_mov_b32 m0, 26624
s_mov_b32 s61, 16809984
buffer_load_dwordx4 v26, s[36:39], s61 offen sc1 lds
s_mov_b32 m0, 27648
s_mov_b32 s61, 16826368
buffer_load_dwordx4 v26, s[36:39], s61 offen sc1 lds
s_mov_b32 m0, 28672
s_mov_b32 s61, 16842752
buffer_load_dwordx4 v26, s[36:39], s61 offen sc1 lds
s_mov_b32 m0, 29696
s_mov_b32 s61, 16859136
buffer_load_dwordx4 v26, s[36:39], s61 offen sc1 lds
s_mov_b32 m0, 30720
s_mov_b32 s61, 16875520
buffer_load_dwordx4 v26, s[36:39], s61 offen sc1 lds
s_mov_b32 m0, 31744
s_mov_b32 s61, 16891904
buffer_load_dwordx4 v26, s[36:39], s61 offen sc1 lds
s_mov_b32 m0, 32768
s_mov_b32 s61, 16908288
buffer_load_dwordx4 v26, s[36:39], s61 offen sc1 lds
s_mov_b32 m0, 33792
s_mov_b32 s61, 16924672
buffer_load_dwordx4 v26, s[36:39], s61 offen sc1 lds
s_mov_b32 m0, 34816
s_mov_b32 s61, 16941056
buffer_load_dwordx4 v26, s[36:39], s61 offen sc1 lds
s_mov_b32 m0, 35840
s_mov_b32 s61, 16957440
buffer_load_dwordx4 v26, s[36:39], s61 offen sc1 lds
s_mov_b32 m0, 36864
s_mov_b32 s61, 16973824
buffer_load_dwordx4 v26, s[36:39], s61 offen sc1 lds
s_mov_b32 m0, 37888
s_mov_b32 s61, 16990208
buffer_load_dwordx4 v26, s[36:39], s61 offen sc1 lds
s_mov_b32 m0, 38912
s_mov_b32 s61, 17006592
buffer_load_dwordx4 v26, s[36:39], s61 offen sc1 lds
s_mov_b32 m0, 39936
s_mov_b32 s61, 17022976
buffer_load_dwordx4 v26, s[36:39], s61 offen sc1 lds
s_barrier
s_barrier
s_barrier
s_waitcnt vmcnt(0)
s_barrier
s_branch Lgend
Lgload:
ds_read_b32 v100, v27 offset:64
s_waitcnt lgkmcnt(0)
v_readfirstlane_b32 s62, v100
s_sub_u32 s68, s62, 1
s_and_b32 s68, s68, 15
s_mul_i32 s68, s68, s65
s_add_u32 s68, s68, s66
s_cmp_lg_u32 s62, 0
s_cbranch_scc1 Ltx158
s_mov_b32 s61, 0
Lto157:
ds_read_b32 v100, v27 offset:64
s_waitcnt lgkmcnt(0)
v_readfirstlane_b32 s62, v100
s_sub_u32 s68, s62, 1
s_and_b32 s68, s68, 15
s_mul_i32 s68, s68, s65
s_add_u32 s68, s68, s66
s_add_u32 s61, s61, 1
s_cmp_lg_u32 s62, 0
s_cbranch_scc1 Ltx158
s_cmp_lt_u32 s61, 1048576
s_cbranch_scc1 Lto157
Ltx158:
s_mov_b32 s67, s68
s_add_u32 m0, s64, 85248
s_nop 0
buffer_load_dwordx4 v20, s[28:31], s67 offen sc1 lds
s_add_u32 m0, s64, 86272
s_add_u32 s60, s67, 16384
buffer_load_dwordx4 v21, s[28:31], s60 offen sc1 lds
s_add_u32 m0, s64, 87296
s_add_u32 s60, s67, 32768
buffer_load_dwordx4 v20, s[28:31], s60 offen sc1 lds
s_add_u32 m0, s64, 88320
s_add_u32 s60, s67, 49152
buffer_load_dwordx4 v21, s[28:31], s60 offen sc1 lds
s_add_u32 m0, s64, 89344
s_add_u32 s60, s67, 65536
buffer_load_dwordx4 v20, s[28:31], s60 offen sc1 lds
s_add_u32 m0, s64, 90368
s_add_u32 s60, s67, 81920
buffer_load_dwordx4 v21, s[28:31], s60 offen sc1 lds
s_add_u32 m0, s64, 91392
s_add_u32 s60, s67, 98304
buffer_load_dwordx4 v20, s[28:31], s60 offen sc1 lds
s_add_u32 m0, s64, 92416
s_add_u32 s60, s67, 114688
buffer_load_dwordx4 v21, s[28:31], s60 offen sc1 lds
ds_read_b32 v100, v27 offset:68
s_waitcnt lgkmcnt(0)
v_readfirstlane_b32 s62, v100
s_sub_u32 s68, s62, 1
s_and_b32 s68, s68, 15
s_mul_i32 s68, s68, s65
s_add_u32 s68, s68, s66
s_cmp_lg_u32 s62, 0
s_cbranch_scc1 Ltx160
s_mov_b32 s61, 0
Lto159:
ds_read_b32 v100, v27 offset:68
s_waitcnt lgkmcnt(0)
v_readfirstlane_b32 s62, v100
s_sub_u32 s68, s62, 1
s_and_b32 s68, s68, 15
s_mul_i32 s68, s68, s65
s_add_u32 s68, s68, s66
s_add_u32 s61, s61, 1
s_cmp_lg_u32 s62, 0
s_cbranch_scc1 Ltx160
s_cmp_lt_u32 s61, 1048576
s_cbranch_scc1 Lto159
Ltx160:
s_mov_b32 s67, s68
s_add_u32 m0, s64, 109824
s_nop 0
buffer_load_dwordx4 v20, s[28:31], s67 offen sc1 lds
s_add_u32 m0, s64, 110848
s_add_u32 s60, s67, 16384
buffer_load_dwordx4 v21, s[28:31], s60 offen sc1 lds
s_add_u32 m0, s64, 111872
s_add_u32 s60, s67, 32768
buffer_load_dwordx4 v20, s[28:31], s60 offen sc1 lds
s_add_u32 m0, s64, 112896
s_add_u32 s60, s67, 49152
buffer_load_dwordx4 v21, s[28:31], s60 offen sc1 lds
s_add_u32 m0, s64, 113920
s_add_u32 s60, s67, 65536
buffer_load_dwordx4 v20, s[28:31], s60 offen sc1 lds
s_add_u32 m0, s64, 114944
s_add_u32 s60, s67, 81920
buffer_load_dwordx4 v21, s[28:31], s60 offen sc1 lds
s_add_u32 m0, s64, 115968
s_add_u32 s60, s67, 98304
buffer_load_dwordx4 v20, s[28:31], s60 offen sc1 lds
s_add_u32 m0, s64, 116992
s_add_u32 s60, s67, 114688
buffer_load_dwordx4 v21, s[28:31], s60 offen sc1 lds
ds_read_b32 v100, v27 offset:72
s_waitcnt lgkmcnt(0)
v_readfirstlane_b32 s62, v100
s_sub_u32 s68, s62, 1
s_and_b32 s68, s68, 15
s_mul_i32 s68, s68, s65
s_add_u32 s68, s68, s66
s_cmp_lg_u32 s62, 0
s_cbranch_scc1 Ltx162
s_mov_b32 s61, 0
Lto161:
ds_read_b32 v100, v27 offset:72
s_waitcnt lgkmcnt(0)
v_readfirstlane_b32 s62, v100
s_sub_u32 s68, s62, 1
s_and_b32 s68, s68, 15
s_mul_i32 s68, s68, s65
s_add_u32 s68, s68, s66
s_add_u32 s61, s61, 1
s_cmp_lg_u32 s62, 0
s_cbranch_scc1 Ltx162
s_cmp_lt_u32 s61, 1048576
s_cbranch_scc1 Lto161
Ltx162:
s_mov_b32 s67, s68
s_mov_b32 s61, 0
Lsp163:
ds_read_b32 v8, v9 offset:42476
s_waitcnt lgkmcnt(0)
v_readfirstlane_b32 s60, v8
s_add_u32 s61, s61, 1
s_cmp_ge_u32 s60, 4
s_cbranch_scc1 Lsx164
s_cmp_lt_u32 s61, 1048576
s_cbranch_scc1 Lsp163
Lsx164:
s_add_u32 m0, s64, 134400
s_nop 0
buffer_load_dwordx4 v20, s[28:31], s67 offen sc1 lds
s_add_u32 m0, s64, 135424
s_add_u32 s60, s67, 16384
buffer_load_dwordx4 v21, s[28:31], s60 offen sc1 lds
ds_read_b32 v100, v27 offset:76
s_add_u32 m0, s64, 136448
s_add_u32 s60, s67, 32768
buffer_load_dwordx4 v20, s[28:31], s60 offen sc1 lds
s_add_u32 m0, s64, 137472
s_add_u32 s60, s67, 49152
buffer_load_dwordx4 v21, s[28:31], s60 offen sc1 lds
s_add_u32 m0, s64, 138496
s_add_u32 s60, s67, 65536
buffer_load_dwordx4 v20, s[28:31], s60 offen sc1 lds
s_add_u32 m0, s64, 139520
s_add_u32 s60, s67, 81920
buffer_load_dwordx4 v21, s[28:31], s60 offen sc1 lds
s_waitcnt lgkmcnt(0)
v_readfirstlane_b32 s62, v100
s_sub_u32 s68, s62, 1
s_and_b32 s68, s68, 15
s_mul_i32 s68, s68, s65
s_add_u32 s68, s68, s66
s_add_u32 m0, s64, 140544
s_add_u32 s60, s67, 98304
buffer_load_dwordx4 v20, s[28:31], s60 offen sc1 lds
s_add_u32 m0, s64, 141568
s_add_u32 s60, s67, 114688
buffer_load_dwordx4 v21, s[28:31], s60 offen sc1 lds
s_cmp_lg_u32 s62, 0
s_cbranch_scc1 Ltx166
s_mov_b32 s61, 0
Lto165:
ds_read_b32 v100, v27 offset:76
s_waitcnt lgkmcnt(0)
v_readfirstlane_b32 s62, v100
s_sub_u32 s68, s62, 1
s_and_b32 s68, s68, 15
s_mul_i32 s68, s68, s65
s_add_u32 s68, s68, s66
s_add_u32 s61, s61, 1
s_cmp_lg_u32 s62, 0
s_cbranch_scc1 Ltx166
s_cmp_lt_u32 s61, 1048576
s_cbranch_scc1 Lto165
Ltx166:
s_mov_b32 s67, s68
s_add_u32 m0, s64, 0
s_waitcnt vmcnt(16)
s_barrier
buffer_load_dwordx4 v20, s[28:31], s67 offen sc1 lds
s_add_u32 m0, s64, 1024
s_add_u32 s60, s67, 16384
buffer_load_dwordx4 v21, s[28:31], s60 offen sc1 lds
ds_read_b32 v100, v27 offset:80
s_add_u32 m0, s64, 2048
s_add_u32 s60, s67, 32768
buffer_load_dwordx4 v20, s[28:31], s60 offen sc1 lds
s_add_u32 m0, s64, 3072
s_add_u32 s60, s67, 49152
buffer_load_dwordx4 v21, s[28:31], s60 offen sc1 lds
s_add_u32 m0, s64, 4096
s_add_u32 s60, s67, 65536
buffer_load_dwordx4 v20, s[28:31], s60 offen sc1 lds
s_add_u32 m0, s64, 5120
s_add_u32 s60, s67, 81920
buffer_load_dwordx4 v21, s[28:31], s60 offen sc1 lds
s_waitcnt lgkmcnt(0)
v_readfirstlane_b32 s62, v100
s_sub_u32 s68, s62, 1
s_and_b32 s68, s68, 15
s_mul_i32 s68, s68, s65
s_add_u32 s68, s68, s66
s_add_u32 m0, s64, 6144
s_add_u32 s60, s67, 98304
buffer_load_dwordx4 v20, s[28:31], s60 offen sc1 lds
s_add_u32 m0, s64, 7168
s_add_u32 s60, s67, 114688
buffer_load_dwordx4 v21, s[28:31], s60 offen sc1 lds
s_cmp_lg_u32 s62, 0
s_cbranch_scc1 Ltx168
s_mov_b32 s61, 0
Lto167:
ds_read_b32 v100, v27 offset:80
s_waitcnt lgkmcnt(0)
v_readfirstlane_b32 s62, v100
s_sub_u32 s68, s62, 1
s_and_b32 s68, s68, 15
s_mul_i32 s68, s68, s65
s_add_u32 s68, s68, s66
s_add_u32 s61, s61, 1
s_cmp_lg_u32 s62, 0
s_cbranch_scc1 Ltx168
s_cmp_lt_u32 s61, 1048576
s_cbranch_scc1 Lto167
Ltx168:
s_mov_b32 s67, s68
s_add_u32 m0, s64, 24576
s_nop 0
buffer_load_dwordx4 v20, s[28:31], s67 offen sc1 lds
s_add_u32 m0, s64, 25600
s_add_u32 s60, s67, 16384
buffer_load_dwordx4 v21, s[28:31], s60 offen sc1 lds
ds_read_b32 v100, v27 offset:84
s_add_u32 m0, s64, 26624
s_add_u32 s60, s67, 32768
buffer_load_dwordx4 v20, s[28:31], s60 offen sc1 lds
s_add_u32 m0, s64, 27648
s_add_u32 s60, s67, 49152
buffer_load_dwordx4 v21, s[28:31], s60 offen sc1 lds
s_add_u32 m0, s64, 28672
s_add_u32 s60, s67, 65536
buffer_load_dwordx4 v20, s[28:31], s60 offen sc1 lds
s_add_u32 m0, s64, 29696
s_add_u32 s60, s67, 81920
buffer_load_dwordx4 v21, s[28:31], s60 offen sc1 lds
s_waitcnt lgkmcnt(0)
v_readfirstlane_b32 s62, v100
s_sub_u32 s68, s62, 1
s_and_b32 s68, s68, 15
s_mul_i32 s68, s68, s65
s_add_u32 s68, s68, s66
s_add_u32 m0, s64, 30720
s_add_u32 s60, s67, 98304
buffer_load_dwordx4 v20, s[28:31], s60 offen sc1 lds
s_add_u32 m0, s64, 31744
s_add_u32 s60, s67, 114688
buffer_load_dwordx4 v21, s[28:31], s60 offen sc1 lds
s_cmp_lg_u32 s62, 0
s_cbranch_scc1 Ltx170
s_mov_b32 s61, 0
Lto169:
ds_read_b32 v100, v27 offset:84
s_waitcnt lgkmcnt(0)
v_readfirstlane_b32 s62, v100
s_sub_u32 s68, s62, 1
s_and_b32 s68, s68, 15
s_mul_i32 s68, s68, s65
s_add_u32 s68, s68, s66
s_add_u32 s61, s61, 1
s_cmp_lg_u32 s62, 0
s_cbranch_scc1 Ltx170
s_cmp_lt_u32 s61, 1048576
s_cbranch_scc1 Lto169
Ltx170:
s_mov_b32 s67, s68
s_add_u32 m0, s64, 49152
s_waitcnt vmcnt(24)
s_barrier
buffer_load_dwordx4 v20, s[28:31], s67 offen sc1 lds
s_add_u32 m0, s64, 50176
s_add_u32 s60, s67, 16384
buffer_load_dwordx4 v21, s[28:31], s60 offen sc1 lds
ds_read_b32 v100, v27 offset:88
s_add_u32 m0, s64, 51200
s_add_u32 s60, s67, 32768
buffer_load_dwordx4 v20, s[28:31], s60 offen sc1 lds
s_add_u32 m0, s64, 52224
s_add_u32 s60, s67, 49152
buffer_load_dwordx4 v21, s[28:31], s60 offen sc1 lds
s_add_u32 m0, s64, 53248
s_add_u32 s60, s67, 65536
buffer_load_dwordx4 v20, s[28:31], s60 offen sc1 lds
s_add_u32 m0, s64, 54272
s_add_u32 s60, s67, 81920
buffer_load_dwordx4 v21, s[28:31], s60 offen sc1 lds
s_waitcnt lgkmcnt(0)
v_readfirstlane_b32 s62, v100
s_sub_u32 s68, s62, 1
s_and_b32 s68, s68, 15
s_mul_i32 s68, s68, s65
s_add_u32 s68, s68, s66
s_add_u32 m0, s64, 55296
s_add_u32 s60, s67, 98304
buffer_load_dwordx4 v20, s[28:31], s60 offen sc1 lds
s_add_u32 m0, s64, 56320
s_add_u32 s60, s67, 114688
buffer_load_dwordx4 v21, s[28:31], s60 offen sc1 lds
s_cmp_lg_u32 s62, 0
s_cbranch_scc1 Ltx172
s_mov_b32 s61, 0
Lto171:
ds_read_b32 v100, v27 offset:88
s_waitcnt lgkmcnt(0)
v_readfirstlane_b32 s62, v100
s_sub_u32 s68, s62, 1
s_and_b32 s68, s68, 15
s_mul_i32 s68, s68, s65
s_add_u32 s68, s68, s66
s_add_u32 s61, s61, 1
s_cmp_lg_u32 s62, 0
s_cbranch_scc1 Ltx172
s_cmp_lt_u32 s61, 1048576
s_cbranch_scc1 Lto171
Ltx172:
s_mov_b32 s67, s68
s_add_u32 m0, s64, 85248
s_nop 0
buffer_load_dwordx4 v20, s[28:31], s67 offen sc1 lds
s_add_u32 m0, s64, 86272
s_add_u32 s60, s67, 16384
buffer_load_dwordx4 v21, s[28:31], s60 offen sc1 lds
ds_read_b32 v100, v27 offset:92
s_add_u32 m0, s64, 87296
s_add_u32 s60, s67, 32768
buffer_load_dwordx4 v20, s[28:31], s60 offen sc1 lds
s_add_u32 m0, s64, 88320
s_add_u32 s60, s67, 49152
buffer_load_dwordx4 v21, s[28:31], s60 offen sc1 lds
s_add_u32 m0, s64, 89344
s_add_u32 s60, s67, 65536
buffer_load_dwordx4 v20, s[28:31], s60 offen sc1 lds
s_add_u32 m0, s64, 90368
s_add_u32 s60, s67, 81920
buffer_load_dwordx4 v21, s[28:31], s60 offen sc1 lds
s_waitcnt lgkmcnt(0)
v_readfirstlane_b32 s62, v100
s_sub_u32 s68, s62, 1
s_and_b32 s68, s68, 15
s_mul_i32 s68, s68, s65
s_add_u32 s68, s68, s66
s_add_u32 m0, s64, 91392
s_add_u32 s60, s67, 98304
buffer_load_dwordx4 v20, s[28:31], s60 offen sc1 lds
s_add_u32 m0, s64, 92416
s_add_u32 s60, s67, 114688
buffer_load_dwordx4 v21, s[28:31], s60 offen sc1 lds
s_cmp_lg_u32 s62, 0
s_cbranch_scc1 Ltx174
s_mov_b32 s61, 0
Lto173:
ds_read_b32 v100, v27 offset:92
s_waitcnt lgkmcnt(0)
v_readfirstlane_b32 s62, v100
s_sub_u32 s68, s62, 1
s_and_b32 s68, s68, 15
s_mul_i32 s68, s68, s65
s_add_u32 s68, s68, s66
s_add_u32 s61, s61, 1
s_cmp_lg_u32 s62, 0
s_cbranch_scc1 Ltx174
s_cmp_lt_u32 s61, 1048576
s_cbranch_scc1 Lto173
Ltx174:
s_mov_b32 s67, s68
s_add_u32 m0, s64, 109824
s_waitcnt vmcnt(32)
s_barrier
buffer_load_dwordx4 v20, s[28:31], s67 offen sc1 lds
s_add_u32 m0, s64, 110848
s_add_u32 s60, s67, 16384
buffer_load_dwordx4 v21, s[28:31], s60 offen sc1 lds
ds_read_b32 v100, v27 offset:96
s_add_u32 m0, s64, 111872
s_add_u32 s60, s67, 32768
buffer_load_dwordx4 v20, s[28:31], s60 offen sc1 lds
s_add_u32 m0, s64, 112896
s_add_u32 s60, s67, 49152
buffer_load_dwordx4 v21, s[28:31], s60 offen sc1 lds
s_add_u32 m0, s64, 113920
s_add_u32 s60, s67, 65536
buffer_load_dwordx4 v20, s[28:31], s60 offen sc1 lds
s_add_u32 m0, s64, 114944
s_add_u32 s60, s67, 81920
buffer_load_dwordx4 v21, s[28:31], s60 offen sc1 lds
s_waitcnt lgkmcnt(0)
v_readfirstlane_b32 s62, v100
s_sub_u32 s68, s62, 1
s_and_b32 s68, s68, 15
s_mul_i32 s68, s68, s65
s_add_u32 s68, s68, s66
s_add_u32 m0, s64, 115968
s_add_u32 s60, s67, 98304
buffer_load_dwordx4 v20, s[28:31], s60 offen sc1 lds
s_add_u32 m0, s64, 116992
s_add_u32 s60, s67, 114688
buffer_load_dwordx4 v21, s[28:31], s60 offen sc1 lds
s_cmp_lg_u32 s62, 0
s_cbranch_scc1 Ltx176
s_mov_b32 s61, 0
Lto175:
ds_read_b32 v100, v27 offset:96
s_waitcnt lgkmcnt(0)
v_readfirstlane_b32 s62, v100
s_sub_u32 s68, s62, 1
s_and_b32 s68, s68, 15
s_mul_i32 s68, s68, s65
s_add_u32 s68, s68, s66
s_add_u32 s61, s61, 1
s_cmp_lg_u32 s62, 0
s_cbranch_scc1 Ltx176
s_cmp_lt_u32 s61, 1048576
s_cbranch_scc1 Lto175
Ltx176:
s_mov_b32 s67, s68
s_add_u32 m0, s64, 134400
s_waitcnt vmcnt(32)
s_barrier
buffer_load_dwordx4 v20, s[28:31], s67 offen sc1 lds
s_add_u32 m0, s64, 135424
s_add_u32 s60, s67, 16384
buffer_load_dwordx4 v21, s[28:31], s60 offen sc1 lds
ds_read_b32 v100, v27 offset:100
s_add_u32 m0, s64, 136448
s_add_u32 s60, s67, 32768
buffer_load_dwordx4 v20, s[28:31], s60 offen sc1 lds
s_add_u32 m0, s64, 137472
s_add_u32 s60, s67, 49152
buffer_load_dwordx4 v21, s[28:31], s60 offen sc1 lds
s_add_u32 m0, s64, 138496
s_add_u32 s60, s67, 65536
buffer_load_dwordx4 v20, s[28:31], s60 offen sc1 lds
s_add_u32 m0, s64, 139520
s_add_u32 s60, s67, 81920
buffer_load_dwordx4 v21, s[28:31], s60 offen sc1 lds
s_waitcnt lgkmcnt(0)
v_readfirstlane_b32 s62, v100
s_sub_u32 s68, s62, 1
s_and_b32 s68, s68, 15
s_mul_i32 s68, s68, s65
s_add_u32 s68, s68, s66
s_add_u32 m0, s64, 140544
s_add_u32 s60, s67, 98304
buffer_load_dwordx4 v20, s[28:31], s60 offen sc1 lds
s_add_u32 m0, s64, 141568
s_add_u32 s60, s67, 114688
buffer_load_dwordx4 v21, s[28:31], s60 offen sc1 lds
s_cmp_lg_u32 s62, 0
s_cbranch_scc1 Ltx178
s_mov_b32 s61, 0
Lto177:
ds_read_b32 v100, v27 offset:100
s_waitcnt lgkmcnt(0)
v_readfirstlane_b32 s62, v100
s_sub_u32 s68, s62, 1
s_and_b32 s68, s68, 15
s_mul_i32 s68, s68, s65
s_add_u32 s68, s68, s66
s_add_u32 s61, s61, 1
s_cmp_lg_u32 s62, 0
s_cbranch_scc1 Ltx178
s_cmp_lt_u32 s61, 1048576
s_cbranch_scc1 Lto177
Ltx178:
s_mov_b32 s67, s68
s_add_u32 m0, s64, 0
s_waitcnt vmcnt(32)
s_barrier
buffer_load_dwordx4 v20, s[28:31], s67 offen sc1 lds
s_add_u32 m0, s64, 1024
s_add_u32 s60, s67, 16384
buffer_load_dwordx4 v21, s[28:31], s60 offen sc1 lds
ds_read_b32 v100, v27 offset:104
s_add_u32 m0, s64, 2048
s_add_u32 s60, s67, 32768
buffer_load_dwordx4 v20, s[28:31], s60 offen sc1 lds
s_add_u32 m0, s64, 3072
s_add_u32 s60, s67, 49152
buffer_load_dwordx4 v21, s[28:31], s60 offen sc1 lds
s_add_u32 m0, s64, 4096
s_add_u32 s60, s67, 65536
buffer_load_dwordx4 v20, s[28:31], s60 offen sc1 lds
s_add_u32 m0, s64, 5120
s_add_u32 s60, s67, 81920
buffer_load_dwordx4 v21, s[28:31], s60 offen sc1 lds
s_waitcnt lgkmcnt(0)
v_readfirstlane_b32 s62, v100
s_sub_u32 s68, s62, 1
s_and_b32 s68, s68, 15
s_mul_i32 s68, s68, s65
s_add_u32 s68, s68, s66
s_add_u32 m0, s64, 6144
s_add_u32 s60, s67, 98304
buffer_load_dwordx4 v20, s[28:31], s60 offen sc1 lds
s_add_u32 m0, s64, 7168
s_add_u32 s60, s67, 114688
buffer_load_dwordx4 v21, s[28:31], s60 offen sc1 lds
s_cmp_lg_u32 s62, 0
s_cbranch_scc1 Ltx180
s_mov_b32 s61, 0
Lto179:
ds_read_b32 v100, v27 offset:104
s_waitcnt lgkmcnt(0)
v_readfirstlane_b32 s62, v100
s_sub_u32 s68, s62, 1
s_and_b32 s68, s68, 15
s_mul_i32 s68, s68, s65
s_add_u32 s68, s68, s66
s_add_u32 s61, s61, 1
s_cmp_lg_u32 s62, 0
s_cbranch_scc1 Ltx180
s_cmp_lt_u32 s61, 1048576
s_cbranch_scc1 Lto179
Ltx180:
s_mov_b32 s67, s68
s_add_u32 m0, s64, 24576
s_waitcnt vmcnt(32)
s_barrier
buffer_load_dwordx4 v20, s[28:31], s67 offen sc1 lds
s_add_u32 m0, s64, 25600
s_add_u32 s60, s67, 16384
buffer_load_dwordx4 v21, s[28:31], s60 offen sc1 lds
ds_read_b32 v100, v27 offset:108
s_add_u32 m0, s64, 26624
s_add_u32 s60, s67, 32768
buffer_load_dwordx4 v20, s[28:31], s60 offen sc1 lds
s_add_u32 m0, s64, 27648
s_add_u32 s60, s67, 49152
buffer_load_dwordx4 v21, s[28:31], s60 offen sc1 lds
s_add_u32 m0, s64, 28672
s_add_u32 s60, s67, 65536
buffer_load_dwordx4 v20, s[28:31], s60 offen sc1 lds
s_add_u32 m0, s64, 29696
s_add_u32 s60, s67, 81920
buffer_load_dwordx4 v21, s[28:31], s60 offen sc1 lds
s_waitcnt lgkmcnt(0)
v_readfirstlane_b32 s62, v100
s_sub_u32 s68, s62, 1
s_and_b32 s68, s68, 15
s_mul_i32 s68, s68, s65
s_add_u32 s68, s68, s66
s_add_u32 m0, s64, 30720
s_add_u32 s60, s67, 98304
buffer_load_dwordx4 v20, s[28:31], s60 offen sc1 lds
s_add_u32 m0, s64, 31744
s_add_u32 s60, s67, 114688
buffer_load_dwordx4 v21, s[28:31], s60 offen sc1 lds
s_cmp_lg_u32 s62, 0
s_cbranch_scc1 Ltx182
s_mov_b32 s61, 0
Lto181:
ds_read_b32 v100, v27 offset:108
s_waitcnt lgkmcnt(0)
v_readfirstlane_b32 s62, v100
s_sub_u32 s68, s62, 1
s_and_b32 s68, s68, 15
s_mul_i32 s68, s68, s65
s_add_u32 s68, s68, s66
s_add_u32 s61, s61, 1
s_cmp_lg_u32 s62, 0
s_cbranch_scc1 Ltx182
s_cmp_lt_u32 s61, 1048576
s_cbranch_scc1 Lto181
Ltx182:
s_mov_b32 s67, s68
s_add_u32 m0, s64, 49152
s_waitcnt vmcnt(32)
s_barrier
buffer_load_dwordx4 v20, s[28:31], s67 offen sc1 lds
s_add_u32 m0, s64, 50176
s_add_u32 s60, s67, 16384
buffer_load_dwordx4 v21, s[28:31], s60 offen sc1 lds
ds_read_b32 v100, v27 offset:112
s_add_u32 m0, s64, 51200
s_add_u32 s60, s67, 32768
buffer_load_dwordx4 v20, s[28:31], s60 offen sc1 lds
s_add_u32 m0, s64, 52224
s_add_u32 s60, s67, 49152
buffer_load_dwordx4 v21, s[28:31], s60 offen sc1 lds
s_add_u32 m0, s64, 53248
s_add_u32 s60, s67, 65536
buffer_load_dwordx4 v20, s[28:31], s60 offen sc1 lds
s_add_u32 m0, s64, 54272
s_add_u32 s60, s67, 81920
buffer_load_dwordx4 v21, s[28:31], s60 offen sc1 lds
s_waitcnt lgkmcnt(0)
v_readfirstlane_b32 s62, v100
s_sub_u32 s68, s62, 1
s_and_b32 s68, s68, 15
s_mul_i32 s68, s68, s65
s_add_u32 s68, s68, s66
s_add_u32 m0, s64, 55296
s_add_u32 s60, s67, 98304
buffer_load_dwordx4 v20, s[28:31], s60 offen sc1 lds
s_add_u32 m0, s64, 56320
s_add_u32 s60, s67, 114688
buffer_load_dwordx4 v21, s[28:31], s60 offen sc1 lds
s_cmp_lg_u32 s62, 0
s_cbranch_scc1 Ltx184
s_mov_b32 s61, 0
Lto183:
ds_read_b32 v100, v27 offset:112
s_waitcnt lgkmcnt(0)
v_readfirstlane_b32 s62, v100
s_sub_u32 s68, s62, 1
s_and_b32 s68, s68, 15
s_mul_i32 s68, s68, s65
s_add_u32 s68, s68, s66
s_add_u32 s61, s61, 1
s_cmp_lg_u32 s62, 0
s_cbranch_scc1 Ltx184
s_cmp_lt_u32 s61, 1048576
s_cbranch_scc1 Lto183
Ltx184:
s_mov_b32 s67, s68
s_add_u32 m0, s64, 85248
s_waitcnt vmcnt(32)
s_barrier
buffer_load_dwordx4 v20, s[28:31], s67 offen sc1 lds
s_add_u32 m0, s64, 86272
s_add_u32 s60, s67, 16384
buffer_load_dwordx4 v21, s[28:31], s60 offen sc1 lds
ds_read_b32 v100, v27 offset:116
s_add_u32 m0, s64, 87296
s_add_u32 s60, s67, 32768
buffer_load_dwordx4 v20, s[28:31], s60 offen sc1 lds
s_add_u32 m0, s64, 88320
s_add_u32 s60, s67, 49152
buffer_load_dwordx4 v21, s[28:31], s60 offen sc1 lds
s_add_u32 m0, s64, 89344
s_add_u32 s60, s67, 65536
buffer_load_dwordx4 v20, s[28:31], s60 offen sc1 lds
s_add_u32 m0, s64, 90368
s_add_u32 s60, s67, 81920
buffer_load_dwordx4 v21, s[28:31], s60 offen sc1 lds
s_waitcnt lgkmcnt(0)
v_readfirstlane_b32 s62, v100
s_sub_u32 s68, s62, 1
s_and_b32 s68, s68, 15
s_mul_i32 s68, s68, s65
s_add_u32 s68, s68, s66
s_add_u32 m0, s64, 91392
s_add_u32 s60, s67, 98304
buffer_load_dwordx4 v20, s[28:31], s60 offen sc1 lds
s_add_u32 m0, s64, 92416
s_add_u32 s60, s67, 114688
buffer_load_dwordx4 v21, s[28:31], s60 offen sc1 lds
s_cmp_lg_u32 s62, 0
s_cbranch_scc1 Ltx186
s_mov_b32 s61, 0
Lto185:
ds_read_b32 v100, v27 offset:116
s_waitcnt lgkmcnt(0)
v_readfirstlane_b32 s62, v100
s_sub_u32 s68, s62, 1
s_and_b32 s68, s68, 15
s_mul_i32 s68, s68, s65
s_add_u32 s68, s68, s66
s_add_u32 s61, s61, 1
s_cmp_lg_u32 s62, 0
s_cbranch_scc1 Ltx186
s_cmp_lt_u32 s61, 1048576
s_cbranch_scc1 Lto185
Ltx186:
s_mov_b32 s67, s68
s_add_u32 m0, s64, 109824
s_waitcnt vmcnt(32)
s_barrier
buffer_load_dwordx4 v20, s[28:31], s67 offen sc1 lds
s_add_u32 m0, s64, 110848
s_add_u32 s60, s67, 16384
buffer_load_dwordx4 v21, s[28:31], s60 offen sc1 lds
ds_read_b32 v100, v27 offset:120
s_add_u32 m0, s64, 111872
s_add_u32 s60, s67, 32768
buffer_load_dwordx4 v20, s[28:31], s60 offen sc1 lds
s_add_u32 m0, s64, 112896
s_add_u32 s60, s67, 49152
buffer_load_dwordx4 v21, s[28:31], s60 offen sc1 lds
s_add_u32 m0, s64, 113920
s_add_u32 s60, s67, 65536
buffer_load_dwordx4 v20, s[28:31], s60 offen sc1 lds
s_add_u32 m0, s64, 114944
s_add_u32 s60, s67, 81920
buffer_load_dwordx4 v21, s[28:31], s60 offen sc1 lds
s_waitcnt lgkmcnt(0)
v_readfirstlane_b32 s62, v100
s_sub_u32 s68, s62, 1
s_and_b32 s68, s68, 15
s_mul_i32 s68, s68, s65
s_add_u32 s68, s68, s66
s_add_u32 m0, s64, 115968
s_add_u32 s60, s67, 98304
buffer_load_dwordx4 v20, s[28:31], s60 offen sc1 lds
s_add_u32 m0, s64, 116992
s_add_u32 s60, s67, 114688
buffer_load_dwordx4 v21, s[28:31], s60 offen sc1 lds
s_cmp_lg_u32 s62, 0
s_cbranch_scc1 Ltx188
s_mov_b32 s61, 0
Lto187:
ds_read_b32 v100, v27 offset:120
s_waitcnt lgkmcnt(0)
v_readfirstlane_b32 s62, v100
s_sub_u32 s68, s62, 1
s_and_b32 s68, s68, 15
s_mul_i32 s68, s68, s65
s_add_u32 s68, s68, s66
s_add_u32 s61, s61, 1
s_cmp_lg_u32 s62, 0
s_cbranch_scc1 Ltx188
s_cmp_lt_u32 s61, 1048576
s_cbranch_scc1 Lto187
Ltx188:
s_mov_b32 s67, s68
s_add_u32 m0, s64, 134400
s_waitcnt vmcnt(32)
s_barrier
buffer_load_dwordx4 v20, s[28:31], s67 offen sc1 lds
s_add_u32 m0, s64, 135424
s_add_u32 s60, s67, 16384
buffer_load_dwordx4 v21, s[28:31], s60 offen sc1 lds
ds_read_b32 v100, v27 offset:124
s_add_u32 m0, s64, 136448
s_add_u32 s60, s67, 32768
buffer_load_dwordx4 v20, s[28:31], s60 offen sc1 lds
s_add_u32 m0, s64, 137472
s_add_u32 s60, s67, 49152
buffer_load_dwordx4 v21, s[28:31], s60 offen sc1 lds
s_add_u32 m0, s64, 138496
s_add_u32 s60, s67, 65536
buffer_load_dwordx4 v20, s[28:31], s60 offen sc1 lds
s_add_u32 m0, s64, 139520
s_add_u32 s60, s67, 81920
buffer_load_dwordx4 v21, s[28:31], s60 offen sc1 lds
s_waitcnt lgkmcnt(0)
v_readfirstlane_b32 s62, v100
s_sub_u32 s68, s62, 1
s_and_b32 s68, s68, 15
s_mul_i32 s68, s68, s65
s_add_u32 s68, s68, s66
s_add_u32 m0, s64, 140544
s_add_u32 s60, s67, 98304
buffer_load_dwordx4 v20, s[28:31], s60 offen sc1 lds
s_add_u32 m0, s64, 141568
s_add_u32 s60, s67, 114688
buffer_load_dwordx4 v21, s[28:31], s60 offen sc1 lds
s_cmp_lg_u32 s62, 0
s_cbranch_scc1 Ltx190
s_mov_b32 s61, 0
Lto189:
ds_read_b32 v100, v27 offset:124
s_waitcnt lgkmcnt(0)
v_readfirstlane_b32 s62, v100
s_sub_u32 s68, s62, 1
s_and_b32 s68, s68, 15
s_mul_i32 s68, s68, s65
s_add_u32 s68, s68, s66
s_add_u32 s61, s61, 1
s_cmp_lg_u32 s62, 0
s_cbranch_scc1 Ltx190
s_cmp_lt_u32 s61, 1048576
s_cbranch_scc1 Lto189
Ltx190:
s_mov_b32 s67, s68
s_add_u32 m0, s64, 0
s_waitcnt vmcnt(32)
s_barrier
buffer_load_dwordx4 v20, s[28:31], s67 offen sc1 lds
s_add_u32 m0, s64, 1024
s_add_u32 s60, s67, 16384
buffer_load_dwordx4 v21, s[28:31], s60 offen sc1 lds
s_add_u32 m0, s64, 2048
s_add_u32 s60, s67, 32768
buffer_load_dwordx4 v20, s[28:31], s60 offen sc1 lds
s_add_u32 m0, s64, 3072
s_add_u32 s60, s67, 49152
buffer_load_dwordx4 v21, s[28:31], s60 offen sc1 lds
s_add_u32 m0, s64, 4096
s_add_u32 s60, s67, 65536
buffer_load_dwordx4 v20, s[28:31], s60 offen sc1 lds
s_add_u32 m0, s64, 5120
s_add_u32 s60, s67, 81920
buffer_load_dwordx4 v21, s[28:31], s60 offen sc1 lds
s_add_u32 m0, s64, 6144
s_add_u32 s60, s67, 98304
buffer_load_dwordx4 v20, s[28:31], s60 offen sc1 lds
s_add_u32 m0, s64, 7168
s_add_u32 s60, s67, 114688
buffer_load_dwordx4 v21, s[28:31], s60 offen sc1 lds
s_waitcnt vmcnt(32)
s_barrier
s_waitcnt vmcnt(24)
s_barrier
s_waitcnt vmcnt(16)
s_barrier
s_waitcnt vmcnt(8)
s_barrier
s_waitcnt vmcnt(0)
s_barrier
Lgend:
s_waitcnt vmcnt(0)
s_endpgm
.p2align 6
Laux:
s_setprio 3
s_sub_u32 s53, s50, 4
v_lshrrev_b32 v2, 3, v0
v_and_b32 v3, 7, v0
v_lshrrev_b32 v4, 4, v0
s_lshl_b32 s55, s48, 7
s_lshl_b32 s61, s53, 5
s_add_u32 s55, s55, s61
v_add_u32 v5, s55, v2
v_lshlrev_b32 v5, 11, v5
v_xor_b32 v6, v4, v3
v_lshl_add_u32 v8, v6, 4, v5
v_xor_b32 v6, 4, v6
v_lshl_add_u32 v9, v6, 4, v5
v_add_u32 v9, 16384, v9
v_add_u32 v10, 32768, v8
v_add_u32 v11, 32768, v9
v_and_b32 v6, 1, v4
v_lshlrev_b32 v6, 1, v6
v_xor_b32 v6, v6, v3
v_mul_u32_u24 v5, 6144, v2
s_mul_i32 s55, s53, 98304
s_lshl_b32 s61, s49, 7
s_add_u32 s55, s55, s61
v_add_u32 v5, s55, v5
v_lshl_add_u32 v12, v6, 4, v5
v_xor_b32 v6, 4, v6
v_lshl_add_u32 v13, v6, 4, v5
v_add_u32 v13, 49152, v13
v_add_u32 v14, 2048, v12
v_add_u32 v15, 2048, v13
v_add_u32 v16, 4096, v12
v_add_u32 v17, 4096, v13
s_lshl_b32 s64, s53, 12
s_lshl_b32 s65, s53, 11
s_add_u32 s65, s65, 16384
s_lshr_b32 s46, s52, 3
s_add_u32 s46, s46, s52
s_and_b32 s46, s46, 3
s_lshl_b32 s46, s46, 2
s_lshl_b32 s66, s46, 7
s_mul_i32 s67, s46, 393216
s_mov_b32 s68, 0
s_waitcnt lgkmcnt(0)
s_mov_b32 s20, s4
s_mov_b32 s21, s5
s_mov_b32 s22, 4194304
s_mov_b32 s23, 0x00020000
s_mov_b32 s24, s6
s_mov_b32 s25, s7
s_mov_b32 s26, 6291456
s_mov_b32 s27, 0x00020000
s_add_u32 s69, s64, s68
s_add_u32 s55, s65, s68
s_mov_b32 m0, s69
s_nop 0
buffer_load_dwordx4 v8, s[20:23], s66 offen lds
s_add_u32 m0, s69, 1024
s_add_u32 s68, s68, 40960
buffer_load_dwordx4 v9, s[20:23], s66 offen lds
s_add_u32 m0, s69, 2048
s_cmp_eq_u32 s68, 163840
s_cselect_b32 s68, 0, s68
buffer_load_dwordx4 v10, s[20:23], s66 offen lds
s_add_u32 m0, s69, 3072
s_nop 0
buffer_load_dwordx4 v11, s[20:23], s66 offen lds
s_add_u32 m0, s55, 0
s_add_u32 s66, s66, 128
buffer_load_dwordx4 v12, s[24:27], s67 offen lds
s_add_u32 m0, s55, 1024
s_cmp_eq_u32 s66, 2048
s_cselect_b32 s66, 0, s66
buffer_load_dwordx4 v13, s[24:27], s67 offen lds
s_add_u32 m0, s55, 8192
s_nop 0
buffer_load_dwordx4 v14, s[24:27], s67 offen lds
s_add_u32 m0, s55, 9216
s_nop 0
buffer_load_dwordx4 v15, s[24:27], s67 offen lds
s_add_u32 m0, s55, 16384
s_nop 0
buffer_load_dwordx4 v16, s[24:27], s67 offen lds
s_add_u32 m0, s55, 17408
s_nop 0
buffer_load_dwordx4 v17, s[24:27], s67 offen lds
s_add_u32 s67, s67, 393216
s_cmp_eq_u32 s67, 6291456
s_cselect_b32 s67, 0, s67
s_add_u32 s69, s64, s68
s_add_u32 s55, s65, s68
s_mov_b32 m0, s69
s_nop 0
buffer_load_dwordx4 v8, s[20:23], s66 offen lds
s_add_u32 m0, s69, 1024
s_add_u32 s68, s68, 40960
buffer_load_dwordx4 v9, s[20:23], s66 offen lds
s_add_u32 m0, s69, 2048
s_cmp_eq_u32 s68, 163840
s_cselect_b32 s68, 0, s68
buffer_load_dwordx4 v10, s[20:23], s66 offen lds
s_add_u32 m0, s69, 3072
s_nop 0
buffer_load_dwordx4 v11, s[20:23], s66 offen lds
s_add_u32 m0, s55, 0
s_add_u32 s66, s66, 128
buffer_load_dwordx4 v12, s[24:27], s67 offen lds
s_add_u32 m0, s55, 1024
s_cmp_eq_u32 s66, 2048
s_cselect_b32 s66, 0, s66
buffer_load_dwordx4 v13, s[24:27], s67 offen lds
s_add_u32 m0, s55, 8192
s_nop 0
buffer_load_dwordx4 v14, s[24:27], s67 offen lds
s_add_u32 m0, s55, 9216
s_nop 0
buffer_load_dwordx4 v15, s[24:27], s67 offen lds
s_add_u32 m0, s55, 16384
s_nop 0
buffer_load_dwordx4 v16, s[24:27], s67 offen lds
s_add_u32 m0, s55, 17408
s_nop 0
buffer_load_dwordx4 v17, s[24:27], s67 offen lds
s_add_u32 s67, s67, 393216
s_cmp_eq_u32 s67, 6291456
s_cselect_b32 s67, 0, s67
s_load_dwordx4 s[8:11], s[0:1], 32
s_load_dwordx4 s[4:7], s[0:1], 48
s_load_dwordx2 s[16:17], s[0:1], 72
s_load_dwordx2 s[18:19], s[0:1], 16
s_add_u32 s69, s64, s68
s_add_u32 s55, s65, s68
s_mov_b32 m0, s69
s_waitcnt vmcnt(10)
s_barrier
buffer_load_dwordx4 v8, s[20:23], s66 offen lds
s_add_u32 m0, s69, 1024
s_add_u32 s68, s68, 40960
buffer_load_dwordx4 v9, s[20:23], s66 offen lds
s_add_u32 m0, s69, 2048
s_cmp_eq_u32 s68, 163840
s_cselect_b32 s68, 0, s68
buffer_load_dwordx4 v10, s[20:23], s66 offen lds
s_add_u32 m0, s69, 3072
s_nop 0
buffer_load_dwordx4 v11, s[20:23], s66 offen lds
s_add_u32 m0, s55, 0
s_add_u32 s66, s66, 128
buffer_load_dwordx4 v12, s[24:27], s67 offen lds
s_add_u32 m0, s55, 1024
s_cmp_eq_u32 s66, 2048
s_cselect_b32 s66, 0, s66
buffer_load_dwordx4 v13, s[24:27], s67 offen lds
s_add_u32 m0, s55, 8192
s_nop 0
buffer_load_dwordx4 v14, s[24:27], s67 offen lds
s_add_u32 m0, s55, 9216
s_nop 0
buffer_load_dwordx4 v15, s[24:27], s67 offen lds
s_add_u32 m0, s55, 16384
s_nop 0
buffer_load_dwordx4 v16, s[24:27], s67 offen lds
s_add_u32 m0, s55, 17408
s_nop 0
buffer_load_dwordx4 v17, s[24:27], s67 offen lds
s_add_u32 s67, s67, 393216
s_cmp_eq_u32 s67, 6291456
s_cselect_b32 s67, 0, s67
s_waitcnt lgkmcnt(0)
s_mov_b32 s28, s8
s_mov_b32 s29, s9
s_mov_b32 s30, 4194304
s_mov_b32 s31, 0x00020000
s_mov_b32 s32, s10
s_mov_b32 s33, s11
s_mov_b32 s34, 4194304
s_mov_b32 s35, 0x00020000
s_mov_b32 s36, s14
s_mov_b32 s37, s15
s_mov_b32 s38, 20971520
s_mov_b32 s39, 0x00020000
s_mov_b32 s40, s4
s_mov_b32 s41, s5
s_mov_b32 s42, 8192
s_mov_b32 s43, 0x00020000
s_mov_b32 s44, s16
s_mov_b32 s45, s17
s_mov_b32 s46, 2048
s_mov_b32 s47, 0x00020000
s_add_u32 s69, s64, s68
s_add_u32 s55, s65, s68
s_mov_b32 m0, s69
s_waitcnt vmcnt(10)
s_barrier
buffer_load_dwordx4 v8, s[20:23], s66 offen lds
s_add_u32 m0, s69, 1024
s_add_u32 s68, s68, 40960
buffer_load_dwordx4 v9, s[20:23], s66 offen lds
s_add_u32 m0, s69, 2048
s_cmp_eq_u32 s68, 163840
s_cselect_b32 s68, 0, s68
buffer_load_dwordx4 v10, s[20:23], s66 offen lds
s_add_u32 m0, s69, 3072
s_nop 0
buffer_load_dwordx4 v11, s[20:23], s66 offen lds
s_add_u32 m0, s55, 0
s_add_u32 s66, s66, 128
buffer_load_dwordx4 v12, s[24:27], s67 offen lds
s_add_u32 m0, s55, 1024
s_cmp_eq_u32 s66, 2048
s_cselect_b32 s66, 0, s66
buffer_load_dwordx4 v13, s[24:27], s67 offen lds
s_add_u32 m0, s55, 8192
s_nop 0
buffer_load_dwordx4 v14, s[24:27], s67 offen lds
s_add_u32 m0, s55, 9216
s_nop 0
buffer_load_dwordx4 v15, s[24:27], s67 offen lds
s_add_u32 m0, s55, 16384
s_nop 0
buffer_load_dwordx4 v16, s[24:27], s67 offen lds
s_add_u32 m0, s55, 17408
s_nop 0
buffer_load_dwordx4 v17, s[24:27], s67 offen lds
s_add_u32 s67, s67, 393216
s_cmp_eq_u32 s67, 6291456
s_cselect_b32 s67, 0, s67
s_add_u32 s69, s64, s68
s_add_u32 s55, s65, s68
s_mov_b32 m0, s69
s_waitcnt vmcnt(10)
s_barrier
buffer_load_dwordx4 v8, s[20:23], s66 offen lds
s_add_u32 m0, s69, 1024
s_add_u32 s68, s68, 40960
buffer_load_dwordx4 v9, s[20:23], s66 offen lds
s_add_u32 m0, s69, 2048
s_cmp_eq_u32 s68, 163840
s_cselect_b32 s68, 0, s68
buffer_load_dwordx4 v10, s[20:23], s66 offen lds
s_add_u32 m0, s69, 3072
s_nop 0
buffer_load_dwordx4 v11, s[20:23], s66 offen lds
s_add_u32 m0, s55, 0
s_add_u32 s66, s66, 128
buffer_load_dwordx4 v12, s[24:27], s67 offen lds
s_add_u32 m0, s55, 1024
s_cmp_eq_u32 s66, 2048
s_cselect_b32 s66, 0, s66
buffer_load_dwordx4 v13, s[24:27], s67 offen lds
s_add_u32 m0, s55, 8192
s_nop 0
buffer_load_dwordx4 v14, s[24:27], s67 offen lds
s_add_u32 m0, s55, 9216
s_nop 0
buffer_load_dwordx4 v15, s[24:27], s67 offen lds
s_add_u32 m0, s55, 16384
s_nop 0
buffer_load_dwordx4 v16, s[24:27], s67 offen lds
s_add_u32 m0, s55, 17408
s_nop 0
buffer_load_dwordx4 v17, s[24:27], s67 offen lds
s_add_u32 s67, s67, 393216
s_cmp_eq_u32 s67, 6291456
s_cselect_b32 s67, 0, s67
s_add_u32 s69, s64, s68
s_add_u32 s55, s65, s68
s_mov_b32 m0, s69
s_waitcnt vmcnt(10)
s_barrier
buffer_load_dwordx4 v8, s[20:23], s66 offen lds
s_add_u32 m0, s69, 1024
s_add_u32 s68, s68, 40960
buffer_load_dwordx4 v9, s[20:23], s66 offen lds
s_add_u32 m0, s69, 2048
s_cmp_eq_u32 s68, 163840
s_cselect_b32 s68, 0, s68
buffer_load_dwordx4 v10, s[20:23], s66 offen lds
s_add_u32 m0, s69, 3072
s_nop 0
buffer_load_dwordx4 v11, s[20:23], s66 offen lds
s_add_u32 m0, s55, 0
s_add_u32 s66, s66, 128
buffer_load_dwordx4 v12, s[24:27], s67 offen lds
s_add_u32 m0, s55, 1024
s_cmp_eq_u32 s66, 2048
s_cselect_b32 s66, 0, s66
buffer_load_dwordx4 v13, s[24:27], s67 offen lds
s_add_u32 m0, s55, 8192
s_nop 0
buffer_load_dwordx4 v14, s[24:27], s67 offen lds
s_add_u32 m0, s55, 9216
s_nop 0
buffer_load_dwordx4 v15, s[24:27], s67 offen lds
s_add_u32 m0, s55, 16384
s_nop 0
buffer_load_dwordx4 v16, s[24:27], s67 offen lds
s_add_u32 m0, s55, 17408
s_nop 0
buffer_load_dwordx4 v17, s[24:27], s67 offen lds
s_add_u32 s67, s67, 393216
s_cmp_eq_u32 s67, 6291456
s_cselect_b32 s67, 0, s67
s_add_u32 s69, s64, s68
s_add_u32 s55, s65, s68
s_mov_b32 m0, s69
s_waitcnt vmcnt(10)
s_barrier
buffer_load_dwordx4 v8, s[20:23], s66 offen lds
s_add_u32 m0, s69, 1024
s_add_u32 s68, s68, 40960
buffer_load_dwordx4 v9, s[20:23], s66 offen lds
s_add_u32 m0, s69, 2048
s_cmp_eq_u32 s68, 163840
s_cselect_b32 s68, 0, s68
buffer_load_dwordx4 v10, s[20:23], s66 offen lds
s_add_u32 m0, s69, 3072
s_nop 0
buffer_load_dwordx4 v11, s[20:23], s66 offen lds
s_add_u32 m0, s55, 0
s_add_u32 s66, s66, 128
buffer_load_dwordx4 v12, s[24:27], s67 offen lds
s_add_u32 m0, s55, 1024
s_cmp_eq_u32 s66, 2048
s_cselect_b32 s66, 0, s66
buffer_load_dwordx4 v13, s[24:27], s67 offen lds
s_add_u32 m0, s55, 8192
s_nop 0
buffer_load_dwordx4 v14, s[24:27], s67 offen lds
s_add_u32 m0, s55, 9216
s_nop 0
buffer_load_dwordx4 v15, s[24:27], s67 offen lds
s_add_u32 m0, s55, 16384
s_nop 0
buffer_load_dwordx4 v16, s[24:27], s67 offen lds
s_add_u32 m0, s55, 17408
s_nop 0
buffer_load_dwordx4 v17, s[24:27], s67 offen lds
s_add_u32 s67, s67, 393216
s_cmp_eq_u32 s67, 6291456
s_cselect_b32 s67, 0, s67
s_add_u32 s69, s64, s68
s_add_u32 s55, s65, s68
s_mov_b32 m0, s69
s_nop 0
buffer_load_dwordx4 v8, s[20:23], s66 offen lds
s_add_u32 m0, s69, 1024
s_add_u32 s68, s68, 40960
buffer_load_dwordx4 v9, s[20:23], s66 offen lds
s_add_u32 m0, s69, 2048
s_cmp_eq_u32 s68, 163840
s_cselect_b32 s68, 0, s68
buffer_load_dwordx4 v10, s[20:23], s66 offen lds
s_add_u32 m0, s69, 3072
s_nop 0
buffer_load_dwordx4 v11, s[20:23], s66 offen lds
s_add_u32 m0, s55, 0
s_add_u32 s66, s66, 128
buffer_load_dwordx4 v12, s[24:27], s67 offen lds
s_add_u32 m0, s55, 1024
s_cmp_eq_u32 s66, 2048
s_cselect_b32 s66, 0, s66
buffer_load_dwordx4 v13, s[24:27], s67 offen lds
s_add_u32 m0, s55, 8192
s_nop 0
buffer_load_dwordx4 v14, s[24:27], s67 offen lds
s_add_u32 m0, s55, 9216
s_nop 0
buffer_load_dwordx4 v15, s[24:27], s67 offen lds
s_add_u32 m0, s55, 16384
s_nop 0
buffer_load_dwordx4 v16, s[24:27], s67 offen lds
s_add_u32 m0, s55, 17408
s_nop 0
buffer_load_dwordx4 v17, s[24:27], s67 offen lds
s_add_u32 s67, s67, 393216
s_cmp_eq_u32 s67, 6291456
s_cselect_b32 s67, 0, s67
s_mov_b32 s60, 5
.p2align 6
Llloop:
s_add_u32 s69, s64, s68
s_add_u32 s55, s65, s68
s_mov_b32 m0, s69
s_add_u32 s60, s60, 1
s_waitcnt vmcnt(20)
s_barrier
buffer_load_dwordx4 v8, s[20:23], s66 offen lds
s_add_u32 m0, s69, 1024
s_add_u32 s68, s68, 40960
buffer_load_dwordx4 v9, s[20:23], s66 offen lds
s_add_u32 m0, s69, 2048
s_cmp_eq_u32 s68, 163840
s_cselect_b32 s68, 0, s68
buffer_load_dwordx4 v10, s[20:23], s66 offen lds
s_add_u32 m0, s69, 3072
s_nop 0
buffer_load_dwordx4 v11, s[20:23], s66 offen lds
s_add_u32 m0, s55, 0
s_add_u32 s66, s66, 128
buffer_load_dwordx4 v12, s[24:27], s67 offen lds
s_add_u32 m0, s55, 1024
s_cmp_eq_u32 s66, 2048
s_cselect_b32 s66, 0, s66
buffer_load_dwordx4 v13, s[24:27], s67 offen lds
s_add_u32 m0, s55, 8192
s_nop 0
buffer_load_dwordx4 v14, s[24:27], s67 offen lds
s_add_u32 m0, s55, 9216
s_nop 0
buffer_load_dwordx4 v15, s[24:27], s67 offen lds
s_add_u32 m0, s55, 16384
s_nop 0
buffer_load_dwordx4 v16, s[24:27], s67 offen lds
s_add_u32 m0, s55, 17408
s_nop 0
buffer_load_dwordx4 v17, s[24:27], s67 offen lds
s_add_u32 s67, s67, 393216
s_cmp_eq_u32 s67, 6291456
s_cselect_b32 s67, 0, s67
s_cmp_lt_u32 s60, 13
s_cbranch_scc1 Llloop
v_mov_b32 v160, 0
v_mov_b32 v161, 0
v_mov_b32 v162, 0
v_mov_b32 v163, 0
v_and_b32 v164, 1, v0
v_lshlrev_b32 v164, 4, v164
s_waitcnt vmcnt(20)
s_barrier
ds_write_b128 v164, v[160:163] offset:21216
s_and_b32 s70, s2, 15
s_lshr_b32 s71, s2, 4
v_lshrrev_b32 v20, 3, v0
v_and_b32 v21, 7, v0
s_lshl_b32 s72, s70, 7
s_lshl_b32 s73, s53, 5
s_add_u32 s72, s72, s73
v_lshl_add_u32 v22, v20, 2, s72
s_lshl_b32 s73, s71, 6
v_lshl_add_u32 v23, v21, 3, s73
v_lshlrev_b32 v24, 11, v22
v_lshl_add_u32 v24, v23, 1, v24
v_subrev_u32 v25, 6144, v24
buffer_load_dwordx4 v[32:35], v25, s[28:31], 0 offen nt
v_add_u32 v25, 2048, v25
buffer_load_dwordx4 v[36:39], v25, s[28:31], 0 offen nt
v_add_u32 v25, 2048, v25
buffer_load_dwordx4 v[40:43], v25, s[28:31], 0 offen nt
v_add_u32 v25, 2048, v25
buffer_load_dwordx4 v[44:47], v25, s[28:31], 0 offen nt
v_add_u32 v25, 2048, v25
buffer_load_dwordx4 v[48:51], v25, s[28:31], 0 offen nt
v_add_u32 v25, 2048, v25
buffer_load_dwordx4 v[52:55], v25, s[28:31], 0 offen nt
v_add_u32 v25, 2048, v25
buffer_load_dwordx4 v[56:59], v25, s[28:31], 0 offen nt
v_add_u32 v26, 4096, v24
buffer_load_dwordx4 v[60:63], v24, s[32:35], 0 offen offset:0 nt
buffer_load_dwordx4 v[64:67], v24, s[32:35], 0 offen offset:2048 nt
buffer_load_dwordx4 v[68:71], v26, s[32:35], 0 offen offset:0 nt
buffer_load_dwordx4 v[72:75], v26, s[32:35], 0 offen offset:2048 nt
s_waitcnt vmcnt(21)
s_barrier
ds_write_b128 v164, v[160:163] offset:42464
v_lshlrev_b32 v27, 3, v23
buffer_load_dwordx4 v[76:79], v27, s[40:43], 0 offen offset:0
buffer_load_dwordx4 v[80:83], v27, s[40:43], 0 offen offset:16
buffer_load_dwordx4 v[84:87], v27, s[40:43], 0 offen offset:32
buffer_load_dwordx4 v[88:91], v27, s[40:43], 0 offen offset:48
s_lshl_b32 s73, s48, 7
s_lshl_b32 s74, s49, 3
s_add_u32 s73, s73, s74
s_lshl_b32 s74, s53, 1
s_add_u32 s73, s73, s74
v_lshrrev_b32 v28, 5, v0
v_add_u32 v28, s73, v28
v_and_b32 v29, 31, v0
v_lshlrev_b32 v29, 4, v29
v_lshl_add_u32 v30, v28, 11, v29
buffer_load_dwordx4 v[92:95], v30, s[20:23], 0 offen offset:0
buffer_load_dwordx4 v[96:99], v30, s[20:23], 0 offen offset:512
buffer_load_dwordx4 v[100:103], v30, s[20:23], 0 offen offset:1024
buffer_load_dwordx4 v[104:107], v30, s[20:23], 0 offen offset:1536
buffer_load_dwordx4 v[108:111], v29, s[44:47], 0 offen offset:0
buffer_load_dwordx4 v[112:115], v29, s[44:47], 0 offen offset:512
buffer_load_dwordx4 v[116:119], v29, s[44:47], 0 offen offset:1024
buffer_load_dwordx4 v[120:123], v29, s[44:47], 0 offen offset:1536
v_lshlrev_b32 v31, 12, v23
v_lshl_add_u32 v31, v22, 1, v31
s_mov_b32 s72, 4194304
s_mov_b32 s74, 0x05040100
s_mov_b32 s75, 0x07060302
s_lshl_b32 s54, s51, 7
s_lshl_b32 s55, s52, 2
s_add_u32 s54, s54, s55
s_add_u32 s54, s54, s53
s_lshl_b32 s55, s54, 12
s_add_u32 s60, s6, s55
s_addc_u32 s61, s7, 0
v_lshlrev_b32 v1, 2, v0
v_subrev_u32 v3, 4, v1
v_add_u32 v4, 252, v1
s_waitcnt vmcnt(23) lgkmcnt(0)
s_barrier
v_and_b32 v165, 7, v0
v_lshlrev_b32 v165, 4, v165
v_add_u32 v165, 84992, v165
ds_write_b128 v165, v[160:163]
s_mov_b32 s24, s60
s_mov_b32 s25, s61
s_mov_b32 s26, 4096
s_mov_b32 s27, 0x00020000
buffer_load_dword v176, v1, s[24:27], 0 offen offset:0 nt
buffer_load_dword v192, v3, s[24:27], 0 offen
buffer_load_dword v177, v1, s[24:27], 0 offen offset:256 nt
buffer_load_dword v193, v4, s[24:27], 0 offen offset:0
buffer_load_dword v178, v1, s[24:27], 0 offen offset:512 nt
buffer_load_dword v194, v4, s[24:27], 0 offen offset:256
buffer_load_dword v179, v1, s[24:27], 0 offen offset:768 nt
buffer_load_dword v195, v4, s[24:27], 0 offen offset:512
buffer_load_dword v180, v1, s[24:27], 0 offen offset:1024 nt
buffer_load_dword v196, v4, s[24:27], 0 offen offset:768
buffer_load_dword v181, v1, s[24:27], 0 offen offset:1280 nt
buffer_load_dword v197, v4, s[24:27], 0 offen offset:1024
buffer_load_dword v182, v1, s[24:27], 0 offen offset:1536 nt
buffer_load_dword v198, v4, s[24:27], 0 offen offset:1280
buffer_load_dword v183, v1, s[24:27], 0 offen offset:1792 nt
buffer_load_dword v199, v4, s[24:27], 0 offen offset:1536
buffer_load_dword v184, v1, s[24:27], 0 offen offset:2048 nt
buffer_load_dword v200, v4, s[24:27], 0 offen offset:1792
buffer_load_dword v185, v1, s[24:27], 0 offen offset:2304 nt
buffer_load_dword v201, v4, s[24:27], 0 offen offset:2048
buffer_load_dword v186, v1, s[24:27], 0 offen offset:2560 nt
buffer_load_dword v202, v4, s[24:27], 0 offen offset:2304
buffer_load_dword v187, v1, s[24:27], 0 offen offset:2816 nt
buffer_load_dword v203, v4, s[24:27], 0 offen offset:2560
buffer_load_dword v188, v1, s[24:27], 0 offen offset:3072 nt
buffer_load_dword v204, v4, s[24:27], 0 offen offset:2816
buffer_load_dword v189, v1, s[24:27], 0 offen offset:3328 nt
buffer_load_dword v205, v4, s[24:27], 0 offen offset:3072
buffer_load_dword v190, v1, s[24:27], 0 offen offset:3584 nt
buffer_load_dword v206, v4, s[24:27], 0 offen offset:3328
buffer_load_dword v191, v1, s[24:27], 0 offen offset:3840 nt
buffer_load_dword v207, v4, s[24:27], 0 offen offset:3584
s_waitcnt vmcnt(40)
v_perm_b32 v128, v32, v36, s74
v_perm_b32 v129, v36, v40, s74
v_perm_b32 v130, v40, v44, s74
v_perm_b32 v131, v44, v48, s74
v_perm_b32 v132, v48, v52, s74
v_perm_b32 v133, v52, v56, s74
v_dot2_f32_bf16 v140, v130, v76, 0
v_dot2_f32_bf16 v141, v131, v76, 0
v_dot2_f32_bf16 v142, v132, v76, 0
v_dot2_f32_bf16 v143, v133, v76, 0
v_dot2_f32_bf16 v140, v128, v77, v140
v_dot2_f32_bf16 v141, v129, v77, v141
v_dot2_f32_bf16 v142, v130, v77, v142
v_dot2_f32_bf16 v143, v131, v77, v143
v_lshlrev_b32 v148, 16, v60
v_lshlrev_b32 v149, 16, v64
v_lshlrev_b32 v150, 16, v68
v_lshlrev_b32 v151, 16, v72
v_mul_f32 v140, v140, v148
v_mul_f32 v141, v141, v149
v_mul_f32 v142, v142, v150
v_mul_f32 v143, v143, v151
v_cvt_pk_bf16_f32 v152, v140, v141
v_cvt_pk_bf16_f32 v153, v142, v143
s_add_u32 s73, s72, 0
buffer_store_dwordx2 v[152:153], v31, s[36:39], s73 offen sc1
v_perm_b32 v134, v32, v36, s75
v_perm_b32 v135, v36, v40, s75
v_perm_b32 v136, v40, v44, s75
v_perm_b32 v137, v44, v48, s75
v_perm_b32 v138, v48, v52, s75
v_perm_b32 v139, v52, v56, s75
v_dot2_f32_bf16 v144, v136, v78, 0
v_dot2_f32_bf16 v145, v137, v78, 0
v_dot2_f32_bf16 v146, v138, v78, 0
v_dot2_f32_bf16 v147, v139, v78, 0
v_dot2_f32_bf16 v144, v134, v79, v144
v_dot2_f32_bf16 v145, v135, v79, v145
v_dot2_f32_bf16 v146, v136, v79, v146
v_dot2_f32_bf16 v147, v137, v79, v147
v_and_b32 v148, 0xffff0000, v60
v_and_b32 v149, 0xffff0000, v64
v_and_b32 v150, 0xffff0000, v68
v_and_b32 v151, 0xffff0000, v72
v_mul_f32 v144, v144, v148
v_mul_f32 v145, v145, v149
v_mul_f32 v146, v146, v150
v_mul_f32 v147, v147, v151
v_cvt_pk_bf16_f32 v154, v144, v145
v_cvt_pk_bf16_f32 v155, v146, v147
s_add_u32 s73, s72, 4096
buffer_store_dwordx2 v[154:155], v31, s[36:39], s73 offen sc1
v_perm_b32 v128, v33, v37, s74
v_perm_b32 v129, v37, v41, s74
v_perm_b32 v130, v41, v45, s74
v_perm_b32 v131, v45, v49, s74
v_perm_b32 v132, v49, v53, s74
v_perm_b32 v133, v53, v57, s74
v_dot2_f32_bf16 v140, v130, v80, 0
v_dot2_f32_bf16 v141, v131, v80, 0
v_dot2_f32_bf16 v142, v132, v80, 0
v_dot2_f32_bf16 v143, v133, v80, 0
v_dot2_f32_bf16 v140, v128, v81, v140
v_dot2_f32_bf16 v141, v129, v81, v141
v_dot2_f32_bf16 v142, v130, v81, v142
v_dot2_f32_bf16 v143, v131, v81, v143
v_lshlrev_b32 v148, 16, v61
v_lshlrev_b32 v149, 16, v65
v_lshlrev_b32 v150, 16, v69
v_lshlrev_b32 v151, 16, v73
v_mul_f32 v140, v140, v148
v_mul_f32 v141, v141, v149
v_mul_f32 v142, v142, v150
v_mul_f32 v143, v143, v151
v_cvt_pk_bf16_f32 v156, v140, v141
v_cvt_pk_bf16_f32 v157, v142, v143
s_add_u32 s73, s72, 8192
buffer_store_dwordx2 v[156:157], v31, s[36:39], s73 offen sc1
v_perm_b32 v134, v33, v37, s75
v_perm_b32 v135, v37, v41, s75
v_perm_b32 v136, v41, v45, s75
v_perm_b32 v137, v45, v49, s75
v_perm_b32 v138, v49, v53, s75
v_perm_b32 v139, v53, v57, s75
v_dot2_f32_bf16 v144, v136, v82, 0
v_dot2_f32_bf16 v145, v137, v82, 0
v_dot2_f32_bf16 v146, v138, v82, 0
v_dot2_f32_bf16 v147, v139, v82, 0
v_dot2_f32_bf16 v144, v134, v83, v144
v_dot2_f32_bf16 v145, v135, v83, v145
v_dot2_f32_bf16 v146, v136, v83, v146
v_dot2_f32_bf16 v147, v137, v83, v147
v_and_b32 v148, 0xffff0000, v61
v_and_b32 v149, 0xffff0000, v65
v_and_b32 v150, 0xffff0000, v69
v_and_b32 v151, 0xffff0000, v73
v_mul_f32 v144, v144, v148
v_mul_f32 v145, v145, v149
v_mul_f32 v146, v146, v150
v_mul_f32 v147, v147, v151
v_cvt_pk_bf16_f32 v158, v144, v145
v_cvt_pk_bf16_f32 v159, v146, v147
s_add_u32 s73, s72, 12288
buffer_store_dwordx2 v[158:159], v31, s[36:39], s73 offen sc1
v_perm_b32 v128, v34, v38, s74
v_perm_b32 v129, v38, v42, s74
v_perm_b32 v130, v42, v46, s74
v_perm_b32 v131, v46, v50, s74
v_perm_b32 v132, v50, v54, s74
v_perm_b32 v133, v54, v58, s74
v_dot2_f32_bf16 v140, v130, v84, 0
v_dot2_f32_bf16 v141, v131, v84, 0
v_dot2_f32_bf16 v142, v132, v84, 0
v_dot2_f32_bf16 v143, v133, v84, 0
v_dot2_f32_bf16 v140, v128, v85, v140
v_dot2_f32_bf16 v141, v129, v85, v141
v_dot2_f32_bf16 v142, v130, v85, v142
v_dot2_f32_bf16 v143, v131, v85, v143
v_lshlrev_b32 v148, 16, v62
v_lshlrev_b32 v149, 16, v66
v_lshlrev_b32 v150, 16, v70
v_lshlrev_b32 v151, 16, v74
v_mul_f32 v140, v140, v148
v_mul_f32 v141, v141, v149
v_mul_f32 v142, v142, v150
v_mul_f32 v143, v143, v151
v_cvt_pk_bf16_f32 v152, v140, v141
v_cvt_pk_bf16_f32 v153, v142, v143
s_add_u32 s73, s72, 16384
buffer_store_dwordx2 v[152:153], v31, s[36:39], s73 offen sc1
v_perm_b32 v134, v34, v38, s75
v_perm_b32 v135, v38, v42, s75
v_perm_b32 v136, v42, v46, s75
v_perm_b32 v137, v46, v50, s75
v_perm_b32 v138, v50, v54, s75
v_perm_b32 v139, v54, v58, s75
v_dot2_f32_bf16 v144, v136, v86, 0
v_dot2_f32_bf16 v145, v137, v86, 0
v_dot2_f32_bf16 v146, v138, v86, 0
v_dot2_f32_bf16 v147, v139, v86, 0
v_dot2_f32_bf16 v144, v134, v87, v144
v_dot2_f32_bf16 v145, v135, v87, v145
v_dot2_f32_bf16 v146, v136, v87, v146
v_dot2_f32_bf16 v147, v137, v87, v147
v_and_b32 v148, 0xffff0000, v62
v_and_b32 v149, 0xffff0000, v66
v_and_b32 v150, 0xffff0000, v70
v_and_b32 v151, 0xffff0000, v74
v_mul_f32 v144, v144, v148
v_mul_f32 v145, v145, v149
v_mul_f32 v146, v146, v150
v_mul_f32 v147, v147, v151
v_cvt_pk_bf16_f32 v154, v144, v145
v_cvt_pk_bf16_f32 v155, v146, v147
s_add_u32 s73, s72, 20480
buffer_store_dwordx2 v[154:155], v31, s[36:39], s73 offen sc1
v_perm_b32 v128, v35, v39, s74
v_perm_b32 v129, v39, v43, s74
v_perm_b32 v130, v43, v47, s74
v_perm_b32 v131, v47, v51, s74
v_perm_b32 v132, v51, v55, s74
v_perm_b32 v133, v55, v59, s74
v_dot2_f32_bf16 v140, v130, v88, 0
v_dot2_f32_bf16 v141, v131, v88, 0
v_dot2_f32_bf16 v142, v132, v88, 0
v_dot2_f32_bf16 v143, v133, v88, 0
v_dot2_f32_bf16 v140, v128, v89, v140
v_dot2_f32_bf16 v141, v129, v89, v141
v_dot2_f32_bf16 v142, v130, v89, v142
v_dot2_f32_bf16 v143, v131, v89, v143
v_lshlrev_b32 v148, 16, v63
v_lshlrev_b32 v149, 16, v67
v_lshlrev_b32 v150, 16, v71
v_lshlrev_b32 v151, 16, v75
v_mul_f32 v140, v140, v148
v_mul_f32 v141, v141, v149
v_mul_f32 v142, v142, v150
v_mul_f32 v143, v143, v151
v_cvt_pk_bf16_f32 v156, v140, v141
v_cvt_pk_bf16_f32 v157, v142, v143
s_add_u32 s73, s72, 24576
buffer_store_dwordx2 v[156:157], v31, s[36:39], s73 offen sc1
v_perm_b32 v134, v35, v39, s75
v_perm_b32 v135, v39, v43, s75
v_perm_b32 v136, v43, v47, s75
v_perm_b32 v137, v47, v51, s75
v_perm_b32 v138, v51, v55, s75
v_perm_b32 v139, v55, v59, s75
v_dot2_f32_bf16 v144, v136, v90, 0
v_dot2_f32_bf16 v145, v137, v90, 0
v_dot2_f32_bf16 v146, v138, v90, 0
v_dot2_f32_bf16 v147, v139, v90, 0
v_dot2_f32_bf16 v144, v134, v91, v144
v_dot2_f32_bf16 v145, v135, v91, v145
v_dot2_f32_bf16 v146, v136, v91, v146
v_dot2_f32_bf16 v147, v137, v91, v147
v_and_b32 v148, 0xffff0000, v63
v_and_b32 v149, 0xffff0000, v67
v_and_b32 v150, 0xffff0000, v71
v_and_b32 v151, 0xffff0000, v75
v_mul_f32 v144, v144, v148
v_mul_f32 v145, v145, v149
v_mul_f32 v146, v146, v150
v_mul_f32 v147, v147, v151
v_cvt_pk_bf16_f32 v158, v144, v145
v_cvt_pk_bf16_f32 v159, v146, v147
s_add_u32 s73, s72, 28672
buffer_store_dwordx2 v[158:159], v31, s[36:39], s73 offen sc1
s_waitcnt vmcnt(40)
v_mov_b32 v128, 0
v_dot2_f32_bf16 v128, v92, v108, v128
v_dot2_f32_bf16 v128, v93, v109, v128
v_dot2_f32_bf16 v128, v94, v110, v128
v_dot2_f32_bf16 v128, v95, v111, v128
v_dot2_f32_bf16 v128, v96, v112, v128
v_dot2_f32_bf16 v128, v97, v113, v128
v_dot2_f32_bf16 v128, v98, v114, v128
v_dot2_f32_bf16 v128, v99, v115, v128
v_dot2_f32_bf16 v128, v100, v116, v128
v_dot2_f32_bf16 v128, v101, v117, v128
v_dot2_f32_bf16 v128, v102, v118, v128
v_dot2_f32_bf16 v128, v103, v119, v128
v_dot2_f32_bf16 v128, v104, v120, v128
v_dot2_f32_bf16 v128, v105, v121, v128
v_dot2_f32_bf16 v128, v106, v122, v128
v_dot2_f32_bf16 v128, v107, v123, v128
s_nop 3
v_add_f32_dpp v128, v128, v128 quad_perm:[1,0,3,2] row_mask:0xf bank_mask:0xf
s_nop 1
v_add_f32_dpp v128, v128, v128 quad_perm:[2,3,0,1] row_mask:0xf bank_mask:0xf
s_nop 1
v_add_f32_dpp v128, v128, v128 row_half_mirror row_mask:0xf bank_mask:0xf
s_nop 1
v_add_f32_dpp v128, v128, v128 row_mirror row_mask:0xf bank_mask:0xf
s_nop 1
v_mov_b32 v129, v128
s_nop 1
v_permlane16_swap_b32 v128, v129
s_nop 1
v_add_f32 v128, v128, v129
v_mul_f32 v128, 0xbfb8aa3b, v128
v_exp_f32 v128, v128
s_nop 0
v_add_f32 v128, 1.0, v128
v_rcp_f32 v128, v128
v_lshlrev_b32 v28, 2, v28
v_and_b32 v29, 31, v0
v_cmp_eq_u32 vcc, 0, v29
s_and_saveexec_b64 s[62:63], vcc
s_mov_b32 s73, 11534336
buffer_store_dword v128, v28, s[36:39], s73 offen sc1
s_mov_b64 exec, s[62:63]
v_lshlrev_b32 v2, 4, v0
s_mul_i32 s56, s53, 21248
v_mov_b32 v12, 0
v_mov_b32 v13, 0
v_mov_b32 v14, 0
v_mov_b32 v15, 0
s_add_u32 s57, s56, 16640
v_min_u32 v5, 29, v0
v_lshl_add_u32 v5, v5, 4, s57
ds_write_b128 v5, v[12:15]
v_lshrrev_b32 v5, 3, v0
v_and_b32 v5, 3, v5
v_mul_u32_u24 v5, 4160, v5
v_and_b32 v6, 7, v0
v_lshl_add_u32 v5, v6, 2, v5
s_add_u32 s57, s56, 4100
v_add_u32 v5, s57, v5
ds_write_b32 v5, v12
s_add_u32 s57, s56, 256
v_sub_u32 v16, s57, v1
s_add_u32 s57, s56, 4416
v_sub_u32 v17, s57, v1
s_add_u32 s57, s56, 8580
v_sub_u32 v18, s57, v1
s_add_u32 s57, s56, 12740
v_sub_u32 v19, s57, v1
s_mov_b32 s59, 0xffff
s_waitcnt vmcnt(9)
v_alignbit_b32 v64, v176, v176, 16
v_bfi_b32 v80, s59, v176, v192
v_alignbit_b32 v65, v177, v177, 16
v_bfi_b32 v81, s59, v177, v193
v_alignbit_b32 v66, v178, v178, 16
v_bfi_b32 v82, s59, v178, v194
v_alignbit_b32 v67, v179, v179, 16
v_bfi_b32 v83, s59, v179, v195
v_alignbit_b32 v68, v180, v180, 16
v_bfi_b32 v84, s59, v180, v196
v_alignbit_b32 v69, v181, v181, 16
v_bfi_b32 v85, s59, v181, v197
v_alignbit_b32 v70, v182, v182, 16
v_bfi_b32 v86, s59, v182, v198
v_alignbit_b32 v71, v183, v183, 16
v_bfi_b32 v87, s59, v183, v199
v_alignbit_b32 v72, v184, v184, 16
v_bfi_b32 v88, s59, v184, v200
v_alignbit_b32 v73, v185, v185, 16
v_bfi_b32 v89, s59, v185, v201
v_alignbit_b32 v74, v186, v186, 16
v_bfi_b32 v90, s59, v186, v202
v_alignbit_b32 v75, v187, v187, 16
v_bfi_b32 v91, s59, v187, v203
v_alignbit_b32 v76, v188, v188, 16
v_bfi_b32 v92, s59, v188, v204
v_alignbit_b32 v77, v189, v189, 16
v_bfi_b32 v93, s59, v189, v205
v_alignbit_b32 v78, v190, v190, 16
v_bfi_b32 v94, s59, v190, v206
v_alignbit_b32 v79, v191, v191, 16
v_bfi_b32 v95, s59, v191, v207
ds_write2st64_b32 v16, v80, v81 offset0:15 offset1:14
ds_write2st64_b32 v17, v64, v65 offset0:15 offset1:14
ds_write2st64_b32 v18, v80, v81 offset0:15 offset1:14
ds_write2st64_b32 v19, v64, v65 offset0:15 offset1:14
ds_write2st64_b32 v16, v82, v83 offset0:13 offset1:12
ds_write2st64_b32 v17, v66, v67 offset0:13 offset1:12
ds_write2st64_b32 v18, v82, v83 offset0:13 offset1:12
ds_write2st64_b32 v19, v66, v67 offset0:13 offset1:12
ds_write2st64_b32 v16, v84, v85 offset0:11 offset1:10
ds_write2st64_b32 v17, v68, v69 offset0:11 offset1:10
ds_write2st64_b32 v18, v84, v85 offset0:11 offset1:10
ds_write2st64_b32 v19, v68, v69 offset0:11 offset1:10
ds_write2st64_b32 v16, v86, v87 offset0:9 offset1:8
ds_write2st64_b32 v17, v70, v71 offset0:9 offset1:8
ds_write2st64_b32 v18, v86, v87 offset0:9 offset1:8
ds_write2st64_b32 v19, v70, v71 offset0:9 offset1:8
ds_write2st64_b32 v16, v88, v89 offset0:7 offset1:6
ds_write2st64_b32 v17, v72, v73 offset0:7 offset1:6
ds_write2st64_b32 v18, v88, v89 offset0:7 offset1:6
ds_write2st64_b32 v19, v72, v73 offset0:7 offset1:6
ds_write2st64_b32 v16, v90, v91 offset0:5 offset1:4
ds_write2st64_b32 v17, v74, v75 offset0:5 offset1:4
ds_write2st64_b32 v18, v90, v91 offset0:5 offset1:4
ds_write2st64_b32 v19, v74, v75 offset0:5 offset1:4
ds_write2st64_b32 v16, v92, v93 offset0:3 offset1:2
ds_write2st64_b32 v17, v76, v77 offset0:3 offset1:2
ds_write2st64_b32 v18, v92, v93 offset0:3 offset1:2
ds_write2st64_b32 v19, v76, v77 offset0:3 offset1:2
ds_write2st64_b32 v16, v94, v95 offset0:1 offset1:0
ds_write2st64_b32 v17, v78, v79 offset0:1 offset1:0
ds_write2st64_b32 v18, v94, v95 offset0:1 offset1:0
ds_write2st64_b32 v19, v78, v79 offset0:1 offset1:0
s_load_dwordx2 s[8:9], s[0:1], 64
s_load_dwordx2 s[16:17], s[0:1], 80
s_mov_b32 s40, s12
s_mov_b32 s41, s13
s_mov_b32 s42, 256
s_mov_b32 s43, 0x00020000
s_mov_b32 s24, s18
s_mov_b32 s25, s19
s_mov_b32 s26, 2097152
s_mov_b32 s27, 0x00020000
v_mov_b32 v9, 0
v_mov_b32 v11, 1
s_lshl_b32 s60, s2, 7
s_add_u32 s60, s60, 12091392
v_mov_b32 v10, s60
s_waitcnt vmcnt(0)
s_mov_b64 exec, 1
ds_add_rtn_u32 v8, v9, v11 offset:42464
s_waitcnt lgkmcnt(0)
v_readfirstlane_b32 s60, v8
s_cmp_eq_u32 s60, 3
s_cbranch_scc0 Lcl191
buffer_store_dword v11, v10, s[36:39], 0 offen sc1
Lcl191:
s_mov_b64 exec, -1
s_cmp_eq_u32 s53, 0
s_cbranch_scc1 Lupoll
s_lshl_b32 s60, s52, 5
s_lshl_b32 s61, s53, 3
s_add_u32 s60, s60, s61
s_sub_u32 s60, s60, 8
v_lshrrev_b32 v96, 3, v0
v_add_u32 v96, s60, v96
v_lshlrev_b32 v96, 11, v96
v_and_b32 v97, 7, v0
v_lshl_add_u32 v96, v97, 7, v96
s_lshr_b32 s60, s51, 2
s_lshl_b32 s60, s60, 10
buffer_load_dword v98, v96, s[24:27], s60 offen
s_cmp_eq_u32 s53, 3
s_cbranch_scc0 Lnpf
v_add_u32 v96, 16384, v96
buffer_load_dword v99, v96, s[24:27], s60 offen
Lnpf:
s_mov_b32 s61, 0
Lsp192:
ds_read_b32 v8, v9 offset:42468
s_waitcnt lgkmcnt(0)
v_readfirstlane_b32 s60, v8
s_add_u32 s61, s61, 1
s_cmp_eq_u32 s60, 1
s_cbranch_scc1 Lsx193
s_cmp_lt_u32 s61, 1048576
s_cbranch_scc1 Lsp192
Lsx193:
s_branch Lugo
Lupoll:
s_mov_b32 s61, 0
v_mov_b32 v101, 0
Lzl194:
buffer_load_dword v100, v101, s[40:43], 0 offen sc1
s_waitcnt vmcnt(0)
v_readfirstlane_b32 s60, v100
s_add_u32 s61, s61, 1
s_cmp_ge_u32 s60, 256
s_cbranch_scc1 Lzx195
s_cmp_lt_u32 s61, 131072
s_cbranch_scc1 Lzl194
Lzx195:
s_lshl_b32 s60, s51, 1
s_lshr_b32 s61, s52, 4
s_add_u32 s60, s60, s61
s_lshl_b32 s60, s60, 11
s_add_u32 s60, s60, 12091392
v_and_b32 v102, 15, v0
v_lshl_add_u32 v102, v102, 7, s60
s_mov_b32 s61, 0
Lpl196:
buffer_load_dword v100, v102, s[36:39], 0 offen sc1
s_waitcnt vmcnt(0) lgkmcnt(0)
v_cmp_ne_u32 vcc, 1, v100
s_add_u32 s61, s61, 1
s_nop 2
s_cmp_eq_u64 vcc, 0
s_cbranch_scc1 Lpx197
s_cmp_lt_u32 s61, 131072
s_cbranch_scc1 Lpl196
Lpx197:
ds_write_b32 v9, v11 offset:42468
Lugo:
s_add_u32 s57, s55, 4194304
s_add_u32 m0, s56, 17120
s_add_u32 s60, s57, 0
buffer_load_dwordx4 v2, s[36:39], s60 offen sc1 lds
s_add_u32 m0, s56, 18144
s_add_u32 s60, s57, 1024
buffer_load_dwordx4 v2, s[36:39], s60 offen sc1 lds
s_add_u32 m0, s56, 19168
s_add_u32 s60, s57, 2048
buffer_load_dwordx4 v2, s[36:39], s60 offen sc1 lds
s_add_u32 m0, s56, 20192
s_add_u32 s60, s57, 3072
buffer_load_dwordx4 v2, s[36:39], s60 offen sc1 lds
s_mov_b32 s47, s53
v_and_b32 v2, 15, v0
v_lshrrev_b32 v3, 4, v0
s_waitcnt lgkmcnt(0)
s_lshl_b32 s53, s51, 7
s_lshl_b32 s54, s52, 2
s_add_u32 s53, s53, s54
s_add_u32 s53, s53, s47
s_mul_i32 s54, s47, 21248
v_and_b32 v6, 3, v0
v_mul_u32_u24 v6, 4160, v6
v_bfe_u32 v7, v0, 2, 2
v_lshlrev_b32 v7, 3, v7
v_sub_u32 v6, v6, v7
v_lshl_add_u32 v6, v3, 4, v6
s_add_u32 s55, s54, 480
v_add_u32 v16, s55, v6
v_lshlrev_b32 v6, 5, v2
v_lshl_add_u32 v6, v3, 4, v6
s_add_u32 s55, s54, 17088
v_add_u32 v17, s55, v6
s_lshl_b32 s55, s53, 1
s_and_b32 s55, s55, 0xfffffffc
s_add_u32 s8, s8, s55
s_addc_u32 s9, s9, 0
s_load_dword s70, s[8:9], 0
s_mov_b32 s28, s16
s_mov_b32 s29, s17
s_mov_b32 s30, 4194304
s_mov_b32 s31, 0x00020000
s_lshr_b32 s66, s47, 1
s_and_b32 s67, s47, 1
s_lshl_b32 s55, s96, 7
s_lshl_b32 s61, s66, 6
s_add_u32 s55, s55, s61
v_add_u32 v20, s55, v2
v_lshlrev_b32 v21, 11, v20
s_lshl_b32 s55, s97, 7
s_lshl_b32 s61, s67, 6
s_add_u32 s64, s55, s61
v_lshl_add_u32 v22, v3, 3, s64
v_add_u32 v22, v21, v22
v_lshlrev_b32 v23, 2, v20
v_lshrrev_b32 v24, 1, v2
v_xor_b32 v24, v24, v3
s_lshl_b32 s55, s66, 13
v_lshlrev_b32 v25, 7, v2
v_add_u32 v25, s55, v25
v_lshl_add_u32 v226, v24, 4, v25
v_xor_b32 v26, 4, v24
v_lshl_add_u32 v227, v26, 4, v25
v_add_u32 v224, 85248, v226
v_add_u32 v225, 85248, v227
v_bfe_u32 v26, v0, 2, 2
v_lshl_add_u32 v27, v3, 3, v26
v_lshlrev_b32 v27, 7, v27
v_and_b32 v28, 3, v0
v_lshl_add_u32 v27, v28, 3, v27
v_add_u32 v27, 16384, v27
v_bfe_u32 v28, v0, 3, 1
v_bfe_u32 v29, v0, 4, 1
v_lshl_or_b32 v28, v29, 1, v28
s_lshl_b32 s55, s67, 1
v_xor_b32 v28, s55, v28
v_lshl_add_u32 v230, v28, 5, v27
v_xor_b32 v28, 1, v28
v_lshl_add_u32 v231, v28, 5, v27
v_add_u32 v228, 85248, v230
v_add_u32 v229, 85248, v231
v_mov_b32 v7, v3
s_waitcnt lgkmcnt(0)
s_lshr_b32 s57, s70, 16
s_and_b32 s60, s70, 0xffff
s_and_b32 s61, s53, 1
s_cmp_eq_u32 s61, 0
s_cselect_b32 s57, s60, s57
v_lshrrev_b32 v28, 3, v2
v_add_u32 v28, 2, v28
v_cmp_eq_u32 vcc, v28, v7
v_and_b32 v28, 1, v2
v_lshlrev_b32 v28, 4, v28
v_mov_b32 v29, s57
v_lshlrev_b32 v29, v28, v29
v_cndmask_b32 v29, 0, v29, vcc
v_bfe_u32 v28, v2, 1, 2
v_cmp_eq_u32 vcc, 0, v28
s_nop 1
v_cndmask_b32 v24, 0, v29, vcc
v_cmp_eq_u32 vcc, 1, v28
s_nop 1
v_cndmask_b32 v25, 0, v29, vcc
v_cmp_eq_u32 vcc, 2, v28
s_nop 1
v_cndmask_b32 v26, 0, v29, vcc
v_cmp_eq_u32 vcc, 3, v28
s_nop 1
v_cndmask_b32 v27, 0, v29, vcc
v_mov_b32 v30, 0
v_mov_b32 v31, 1
s_lshl_b32 s55, s53, 12
s_waitcnt vmcnt(0) lgkmcnt(0)
s_setprio 2
ds_read_b64 v[96:97], v16 offset:3584
ds_read_b64 v[98:99], v16 offset:3592
ds_read_b128 v[128:131], v17 offset:0
ds_read_b64 v[100:101], v16 offset:3072
ds_read_b64 v[102:103], v16 offset:3080
ds_read_b128 v[132:135], v17 offset:512
ds_read_b64 v[104:105], v16 offset:2560
ds_read_b64 v[106:107], v16 offset:2568
ds_read_b128 v[136:139], v17 offset:1024
ds_read_b64 v[108:109], v16 offset:2048
ds_read_b64 v[110:111], v16 offset:2056
ds_read_b128 v[140:143], v17 offset:1536
ds_read_b64 v[112:113], v16 offset:1536
ds_read_b64 v[114:115], v16 offset:1544
ds_read_b128 v[144:147], v17 offset:2048
ds_read_b64 v[116:117], v16 offset:1024
ds_read_b64 v[118:119], v16 offset:1032
ds_read_b128 v[148:151], v17 offset:2560
ds_read_b64 v[120:121], v16 offset:512
ds_read_b64 v[122:123], v16 offset:520
ds_read_b128 v[152:155], v17 offset:3072
ds_read_b64 v[124:125], v16 offset:0
ds_read_b64 v[126:127], v16 offset:8
ds_read_b128 v[156:159], v17 offset:3584
v_subrev_u32 v16, 64, v16
v_subrev_u32 v17, 64, v17
s_waitcnt lgkmcnt(0)
v_mfma_f32_16x16x32_bf16 v[32:35], v[96:99], v[128:131], 0
ds_read_b64 v[160:161], v16 offset:3584
v_mfma_f32_16x16x32_bf16 v[36:39], v[96:99], v[132:135], 0
ds_read_b64 v[162:163], v16 offset:3592
v_mfma_f32_16x16x32_bf16 v[40:43], v[96:99], v[136:139], 0
ds_read_b128 v[192:195], v17 offset:0
v_mfma_f32_16x16x32_bf16 v[44:47], v[96:99], v[140:143], 0
ds_read_b64 v[164:165], v16 offset:3072
v_mfma_f32_16x16x32_bf16 v[48:51], v[96:99], v[144:147], 0
ds_read_b64 v[166:167], v16 offset:3080
v_mfma_f32_16x16x32_bf16 v[52:55], v[96:99], v[148:151], 0
ds_read_b128 v[196:199], v17 offset:512
v_mfma_f32_16x16x32_bf16 v[56:59], v[96:99], v[152:155], 0
ds_read_b64 v[168:169], v16 offset:2560
v_mfma_f32_16x16x32_bf16 v[60:63], v[96:99], v[156:159], 0
ds_read_b64 v[170:171], v16 offset:2568
v_mfma_f32_16x16x32_bf16 v[36:39], v[100:103], v[128:131], v[36:39]
ds_read_b128 v[200:203], v17 offset:1024
v_mfma_f32_16x16x32_bf16 v[40:43], v[100:103], v[132:135], v[40:43]
ds_read_b64 v[172:173], v16 offset:2048
v_mfma_f32_16x16x32_bf16 v[44:47], v[100:103], v[136:139], v[44:47]
ds_read_b64 v[174:175], v16 offset:2056
v_mfma_f32_16x16x32_bf16 v[48:51], v[100:103], v[140:143], v[48:51]
ds_read_b128 v[204:207], v17 offset:1536
v_mfma_f32_16x16x32_bf16 v[52:55], v[100:103], v[144:147], v[52:55]
ds_read_b64 v[176:177], v16 offset:1536
v_mfma_f32_16x16x32_bf16 v[56:59], v[100:103], v[148:151], v[56:59]
ds_read_b64 v[178:179], v16 offset:1544
v_mfma_f32_16x16x32_bf16 v[60:63], v[100:103], v[152:155], v[60:63]
ds_read_b128 v[208:211], v17 offset:2048
v_mfma_f32_16x16x32_bf16 v[40:43], v[104:107], v[128:131], v[40:43]
ds_read_b64 v[180:181], v16 offset:1024
v_mfma_f32_16x16x32_bf16 v[44:47], v[104:107], v[132:135], v[44:47]
ds_read_b64 v[182:183], v16 offset:1032
v_mfma_f32_16x16x32_bf16 v[48:51], v[104:107], v[136:139], v[48:51]
ds_read_b128 v[212:215], v17 offset:2560
v_mfma_f32_16x16x32_bf16 v[52:55], v[104:107], v[140:143], v[52:55]
ds_read_b64 v[184:185], v16 offset:512
v_mfma_f32_16x16x32_bf16 v[56:59], v[104:107], v[144:147], v[56:59]
ds_read_b64 v[186:187], v16 offset:520
v_mfma_f32_16x16x32_bf16 v[60:63], v[104:107], v[148:151], v[60:63]
ds_read_b128 v[216:219], v17 offset:3072
v_mfma_f32_16x16x32_bf16 v[44:47], v[108:111], v[128:131], v[44:47]
ds_read_b64 v[188:189], v16 offset:0
v_mfma_f32_16x16x32_bf16 v[48:51], v[108:111], v[132:135], v[48:51]
ds_read_b64 v[190:191], v16 offset:8
v_mfma_f32_16x16x32_bf16 v[52:55], v[108:111], v[136:139], v[52:55]
ds_read_b128 v[220:223], v17 offset:3584
v_mfma_f32_16x16x32_bf16 v[56:59], v[108:111], v[140:143], v[56:59]
v_mfma_f32_16x16x32_bf16 v[60:63], v[108:111], v[144:147], v[60:63]
v_mfma_f32_16x16x32_bf16 v[48:51], v[112:115], v[128:131], v[48:51]
v_mfma_f32_16x16x32_bf16 v[52:55], v[112:115], v[132:135], v[52:55]
v_mfma_f32_16x16x32_bf16 v[56:59], v[112:115], v[136:139], v[56:59]
v_mfma_f32_16x16x32_bf16 v[60:63], v[112:115], v[140:143], v[60:63]
v_mfma_f32_16x16x32_bf16 v[52:55], v[116:119], v[128:131], v[52:55]
v_mfma_f32_16x16x32_bf16 v[56:59], v[116:119], v[132:135], v[56:59]
v_mfma_f32_16x16x32_bf16 v[60:63], v[116:119], v[136:139], v[60:63]
v_mfma_f32_16x16x32_bf16 v[56:59], v[120:123], v[128:131], v[56:59]
v_mfma_f32_16x16x32_bf16 v[60:63], v[120:123], v[132:135], v[60:63]
v_mfma_f32_16x16x32_bf16 v[60:63], v[124:127], v[128:131], v[60:63]
v_mfma_f32_16x16x32_bf16 v[32:35], v[24:27], v[128:131], v[32:35]
v_mfma_f32_16x16x32_bf16 v[36:39], v[24:27], v[132:135], v[36:39]
v_mfma_f32_16x16x32_bf16 v[40:43], v[24:27], v[136:139], v[40:43]
v_mfma_f32_16x16x32_bf16 v[44:47], v[24:27], v[140:143], v[44:47]
v_mfma_f32_16x16x32_bf16 v[48:51], v[24:27], v[144:147], v[48:51]
v_mfma_f32_16x16x32_bf16 v[52:55], v[24:27], v[148:151], v[52:55]
v_mfma_f32_16x16x32_bf16 v[56:59], v[24:27], v[152:155], v[56:59]
v_mfma_f32_16x16x32_bf16 v[60:63], v[24:27], v[156:159], v[60:63]
v_subrev_u32 v16, 64, v16
v_subrev_u32 v17, 64, v17
s_waitcnt lgkmcnt(0)
v_mfma_f32_16x16x32_bf16 v[32:35], v[160:163], v[192:195], v[32:35]
ds_read_b64 v[96:97], v16 offset:3584
v_mfma_f32_16x16x32_bf16 v[36:39], v[160:163], v[196:199], v[36:39]
ds_read_b64 v[98:99], v16 offset:3592
v_mfma_f32_16x16x32_bf16 v[40:43], v[160:163], v[200:203], v[40:43]
ds_read_b128 v[128:131], v17 offset:0
v_mfma_f32_16x16x32_bf16 v[44:47], v[160:163], v[204:207], v[44:47]
ds_read_b64 v[100:101], v16 offset:3072
v_mfma_f32_16x16x32_bf16 v[48:51], v[160:163], v[208:211], v[48:51]
ds_read_b64 v[102:103], v16 offset:3080
v_mfma_f32_16x16x32_bf16 v[52:55], v[160:163], v[212:215], v[52:55]
ds_read_b128 v[132:135], v17 offset:512
v_mfma_f32_16x16x32_bf16 v[56:59], v[160:163], v[216:219], v[56:59]
ds_read_b64 v[104:105], v16 offset:2560
v_mfma_f32_16x16x32_bf16 v[60:63], v[160:163], v[220:223], v[60:63]
ds_read_b64 v[106:107], v16 offset:2568
v_mfma_f32_16x16x32_bf16 v[36:39], v[164:167], v[192:195], v[36:39]
ds_read_b128 v[136:139], v17 offset:1024
v_mfma_f32_16x16x32_bf16 v[40:43], v[164:167], v[196:199], v[40:43]
ds_read_b64 v[108:109], v16 offset:2048
v_mfma_f32_16x16x32_bf16 v[44:47], v[164:167], v[200:203], v[44:47]
ds_read_b64 v[110:111], v16 offset:2056
v_mfma_f32_16x16x32_bf16 v[48:51], v[164:167], v[204:207], v[48:51]
ds_read_b128 v[140:143], v17 offset:1536
v_mfma_f32_16x16x32_bf16 v[52:55], v[164:167], v[208:211], v[52:55]
ds_read_b64 v[112:113], v16 offset:1536
v_mfma_f32_16x16x32_bf16 v[56:59], v[164:167], v[212:215], v[56:59]
ds_read_b64 v[114:115], v16 offset:1544
v_mfma_f32_16x16x32_bf16 v[60:63], v[164:167], v[216:219], v[60:63]
ds_read_b128 v[144:147], v17 offset:2048
v_mfma_f32_16x16x32_bf16 v[40:43], v[168:171], v[192:195], v[40:43]
ds_read_b64 v[116:117], v16 offset:1024
v_mfma_f32_16x16x32_bf16 v[44:47], v[168:171], v[196:199], v[44:47]
ds_read_b64 v[118:119], v16 offset:1032
v_mfma_f32_16x16x32_bf16 v[48:51], v[168:171], v[200:203], v[48:51]
ds_read_b128 v[148:151], v17 offset:2560
v_mfma_f32_16x16x32_bf16 v[52:55], v[168:171], v[204:207], v[52:55]
ds_read_b64 v[120:121], v16 offset:512
v_mfma_f32_16x16x32_bf16 v[56:59], v[168:171], v[208:211], v[56:59]
ds_read_b64 v[122:123], v16 offset:520
v_mfma_f32_16x16x32_bf16 v[60:63], v[168:171], v[212:215], v[60:63]
ds_read_b128 v[152:155], v17 offset:3072
v_mfma_f32_16x16x32_bf16 v[44:47], v[172:175], v[192:195], v[44:47]
ds_read_b64 v[124:125], v16 offset:0
v_mfma_f32_16x16x32_bf16 v[48:51], v[172:175], v[196:199], v[48:51]
ds_read_b64 v[126:127], v16 offset:8
v_mfma_f32_16x16x32_bf16 v[52:55], v[172:175], v[200:203], v[52:55]
ds_read_b128 v[156:159], v17 offset:3584
v_mfma_f32_16x16x32_bf16 v[56:59], v[172:175], v[204:207], v[56:59]
v_mfma_f32_16x16x32_bf16 v[60:63], v[172:175], v[208:211], v[60:63]
v_mfma_f32_16x16x32_bf16 v[48:51], v[176:179], v[192:195], v[48:51]
v_mfma_f32_16x16x32_bf16 v[52:55], v[176:179], v[196:199], v[52:55]
v_mfma_f32_16x16x32_bf16 v[56:59], v[176:179], v[200:203], v[56:59]
v_mfma_f32_16x16x32_bf16 v[60:63], v[176:179], v[204:207], v[60:63]
v_mfma_f32_16x16x32_bf16 v[52:55], v[180:183], v[192:195], v[52:55]
v_mfma_f32_16x16x32_bf16 v[56:59], v[180:183], v[196:199], v[56:59]
v_mfma_f32_16x16x32_bf16 v[60:63], v[180:183], v[200:203], v[60:63]
v_mfma_f32_16x16x32_bf16 v[56:59], v[184:187], v[192:195], v[56:59]
v_mfma_f32_16x16x32_bf16 v[60:63], v[184:187], v[196:199], v[60:63]
v_mfma_f32_16x16x32_bf16 v[60:63], v[188:191], v[192:195], v[60:63]
v_subrev_u32 v16, 64, v16
v_subrev_u32 v17, 64, v17
s_mov_b32 s61, 0
buffer_load_dwordx2 v[232:233], v22, s[20:23], s61 offen offset:0
buffer_load_dwordx2 v[234:235], v22, s[20:23], s61 offen offset:32
s_mov_b32 s61, 32768
buffer_load_dwordx2 v[236:237], v22, s[20:23], s61 offen offset:0
buffer_load_dwordx2 v[238:239], v22, s[20:23], s61 offen offset:32
s_mov_b32 s61, 65536
buffer_load_dwordx2 v[240:241], v22, s[20:23], s61 offen offset:0
buffer_load_dwordx2 v[242:243], v22, s[20:23], s61 offen offset:32
s_mov_b32 s61, 98304
buffer_load_dwordx2 v[244:245], v22, s[20:23], s61 offen offset:0
buffer_load_dwordx2 v[246:247], v22, s[20:23], s61 offen offset:32
s_mov_b32 s60, 0
.p2align 6
Lcl:
s_waitcnt lgkmcnt(0)
v_mfma_f32_16x16x32_bf16 v[32:35], v[96:99], v[128:131], v[32:35]
ds_read_b64 v[160:161], v16 offset:3584
v_mfma_f32_16x16x32_bf16 v[36:39], v[96:99], v[132:135], v[36:39]
ds_read_b64 v[162:163], v16 offset:3592
v_mfma_f32_16x16x32_bf16 v[40:43], v[96:99], v[136:139], v[40:43]
ds_read_b128 v[192:195], v17 offset:0
v_mfma_f32_16x16x32_bf16 v[44:47], v[96:99], v[140:143], v[44:47]
ds_read_b64 v[164:165], v16 offset:3072
v_mfma_f32_16x16x32_bf16 v[48:51], v[96:99], v[144:147], v[48:51]
ds_read_b64 v[166:167], v16 offset:3080
v_mfma_f32_16x16x32_bf16 v[52:55], v[96:99], v[148:151], v[52:55]
ds_read_b128 v[196:199], v17 offset:512
v_mfma_f32_16x16x32_bf16 v[56:59], v[96:99], v[152:155], v[56:59]
ds_read_b64 v[168:169], v16 offset:2560
v_mfma_f32_16x16x32_bf16 v[60:63], v[96:99], v[156:159], v[60:63]
ds_read_b64 v[170:171], v16 offset:2568
v_mfma_f32_16x16x32_bf16 v[36:39], v[100:103], v[128:131], v[36:39]
ds_read_b128 v[200:203], v17 offset:1024
v_mfma_f32_16x16x32_bf16 v[40:43], v[100:103], v[132:135], v[40:43]
ds_read_b64 v[172:173], v16 offset:2048
v_mfma_f32_16x16x32_bf16 v[44:47], v[100:103], v[136:139], v[44:47]
ds_read_b64 v[174:175], v16 offset:2056
v_mfma_f32_16x16x32_bf16 v[48:51], v[100:103], v[140:143], v[48:51]
ds_read_b128 v[204:207], v17 offset:1536
v_mfma_f32_16x16x32_bf16 v[52:55], v[100:103], v[144:147], v[52:55]
ds_read_b64 v[176:177], v16 offset:1536
v_mfma_f32_16x16x32_bf16 v[56:59], v[100:103], v[148:151], v[56:59]
ds_read_b64 v[178:179], v16 offset:1544
v_mfma_f32_16x16x32_bf16 v[60:63], v[100:103], v[152:155], v[60:63]
ds_read_b128 v[208:211], v17 offset:2048
v_mfma_f32_16x16x32_bf16 v[40:43], v[104:107], v[128:131], v[40:43]
ds_read_b64 v[180:181], v16 offset:1024
v_mfma_f32_16x16x32_bf16 v[44:47], v[104:107], v[132:135], v[44:47]
ds_read_b64 v[182:183], v16 offset:1032
v_mfma_f32_16x16x32_bf16 v[48:51], v[104:107], v[136:139], v[48:51]
ds_read_b128 v[212:215], v17 offset:2560
v_mfma_f32_16x16x32_bf16 v[52:55], v[104:107], v[140:143], v[52:55]
ds_read_b64 v[184:185], v16 offset:512
v_mfma_f32_16x16x32_bf16 v[56:59], v[104:107], v[144:147], v[56:59]
ds_read_b64 v[186:187], v16 offset:520
v_mfma_f32_16x16x32_bf16 v[60:63], v[104:107], v[148:151], v[60:63]
ds_read_b128 v[216:219], v17 offset:3072
v_mfma_f32_16x16x32_bf16 v[44:47], v[108:111], v[128:131], v[44:47]
ds_read_b64 v[188:189], v16 offset:0
v_mfma_f32_16x16x32_bf16 v[48:51], v[108:111], v[132:135], v[48:51]
ds_read_b64 v[190:191], v16 offset:8
v_mfma_f32_16x16x32_bf16 v[52:55], v[108:111], v[136:139], v[52:55]
ds_read_b128 v[220:223], v17 offset:3584
v_mfma_f32_16x16x32_bf16 v[56:59], v[108:111], v[140:143], v[56:59]
v_mfma_f32_16x16x32_bf16 v[60:63], v[108:111], v[144:147], v[60:63]
v_mfma_f32_16x16x32_bf16 v[48:51], v[112:115], v[128:131], v[48:51]
v_mfma_f32_16x16x32_bf16 v[52:55], v[112:115], v[132:135], v[52:55]
v_mfma_f32_16x16x32_bf16 v[56:59], v[112:115], v[136:139], v[56:59]
v_mfma_f32_16x16x32_bf16 v[60:63], v[112:115], v[140:143], v[60:63]
v_mfma_f32_16x16x32_bf16 v[52:55], v[116:119], v[128:131], v[52:55]
v_mfma_f32_16x16x32_bf16 v[56:59], v[116:119], v[132:135], v[56:59]
v_mfma_f32_16x16x32_bf16 v[60:63], v[116:119], v[136:139], v[60:63]
v_mfma_f32_16x16x32_bf16 v[56:59], v[120:123], v[128:131], v[56:59]
v_mfma_f32_16x16x32_bf16 v[60:63], v[120:123], v[132:135], v[60:63]
v_mfma_f32_16x16x32_bf16 v[60:63], v[124:127], v[128:131], v[60:63]
v_subrev_u32 v16, 64, v16
v_subrev_u32 v17, 64, v17
s_waitcnt lgkmcnt(0)
v_mfma_f32_16x16x32_bf16 v[32:35], v[160:163], v[192:195], v[32:35]
ds_read_b64 v[96:97], v16 offset:3584
v_mfma_f32_16x16x32_bf16 v[36:39], v[160:163], v[196:199], v[36:39]
ds_read_b64 v[98:99], v16 offset:3592
v_mfma_f32_16x16x32_bf16 v[40:43], v[160:163], v[200:203], v[40:43]
ds_read_b128 v[128:131], v17 offset:0
v_mfma_f32_16x16x32_bf16 v[44:47], v[160:163], v[204:207], v[44:47]
ds_read_b64 v[100:101], v16 offset:3072
v_mfma_f32_16x16x32_bf16 v[48:51], v[160:163], v[208:211], v[48:51]
ds_read_b64 v[102:103], v16 offset:3080
v_mfma_f32_16x16x32_bf16 v[52:55], v[160:163], v[212:215], v[52:55]
ds_read_b128 v[132:135], v17 offset:512
v_mfma_f32_16x16x32_bf16 v[56:59], v[160:163], v[216:219], v[56:59]
ds_read_b64 v[104:105], v16 offset:2560
v_mfma_f32_16x16x32_bf16 v[60:63], v[160:163], v[220:223], v[60:63]
ds_read_b64 v[106:107], v16 offset:2568
v_mfma_f32_16x16x32_bf16 v[36:39], v[164:167], v[192:195], v[36:39]
ds_read_b128 v[136:139], v17 offset:1024
v_mfma_f32_16x16x32_bf16 v[40:43], v[164:167], v[196:199], v[40:43]
ds_read_b64 v[108:109], v16 offset:2048
v_mfma_f32_16x16x32_bf16 v[44:47], v[164:167], v[200:203], v[44:47]
ds_read_b64 v[110:111], v16 offset:2056
v_mfma_f32_16x16x32_bf16 v[48:51], v[164:167], v[204:207], v[48:51]
ds_read_b128 v[140:143], v17 offset:1536
v_mfma_f32_16x16x32_bf16 v[52:55], v[164:167], v[208:211], v[52:55]
ds_read_b64 v[112:113], v16 offset:1536
v_mfma_f32_16x16x32_bf16 v[56:59], v[164:167], v[212:215], v[56:59]
ds_read_b64 v[114:115], v16 offset:1544
v_mfma_f32_16x16x32_bf16 v[60:63], v[164:167], v[216:219], v[60:63]
ds_read_b128 v[144:147], v17 offset:2048
v_mfma_f32_16x16x32_bf16 v[40:43], v[168:171], v[192:195], v[40:43]
ds_read_b64 v[116:117], v16 offset:1024
v_mfma_f32_16x16x32_bf16 v[44:47], v[168:171], v[196:199], v[44:47]
ds_read_b64 v[118:119], v16 offset:1032
v_mfma_f32_16x16x32_bf16 v[48:51], v[168:171], v[200:203], v[48:51]
ds_read_b128 v[148:151], v17 offset:2560
v_mfma_f32_16x16x32_bf16 v[52:55], v[168:171], v[204:207], v[52:55]
ds_read_b64 v[120:121], v16 offset:512
v_mfma_f32_16x16x32_bf16 v[56:59], v[168:171], v[208:211], v[56:59]
ds_read_b64 v[122:123], v16 offset:520
v_mfma_f32_16x16x32_bf16 v[60:63], v[168:171], v[212:215], v[60:63]
ds_read_b128 v[152:155], v17 offset:3072
v_mfma_f32_16x16x32_bf16 v[44:47], v[172:175], v[192:195], v[44:47]
ds_read_b64 v[124:125], v16 offset:0
v_mfma_f32_16x16x32_bf16 v[48:51], v[172:175], v[196:199], v[48:51]
ds_read_b64 v[126:127], v16 offset:8
v_mfma_f32_16x16x32_bf16 v[52:55], v[172:175], v[200:203], v[52:55]
ds_read_b128 v[156:159], v17 offset:3584
v_mfma_f32_16x16x32_bf16 v[56:59], v[172:175], v[204:207], v[56:59]
v_mfma_f32_16x16x32_bf16 v[60:63], v[172:175], v[208:211], v[60:63]
v_mfma_f32_16x16x32_bf16 v[48:51], v[176:179], v[192:195], v[48:51]
v_mfma_f32_16x16x32_bf16 v[52:55], v[176:179], v[196:199], v[52:55]
v_mfma_f32_16x16x32_bf16 v[56:59], v[176:179], v[200:203], v[56:59]
v_mfma_f32_16x16x32_bf16 v[60:63], v[176:179], v[204:207], v[60:63]
v_mfma_f32_16x16x32_bf16 v[52:55], v[180:183], v[192:195], v[52:55]
v_mfma_f32_16x16x32_bf16 v[56:59], v[180:183], v[196:199], v[56:59]
v_mfma_f32_16x16x32_bf16 v[60:63], v[180:183], v[200:203], v[60:63]
v_mfma_f32_16x16x32_bf16 v[56:59], v[184:187], v[192:195], v[56:59]
v_mfma_f32_16x16x32_bf16 v[60:63], v[184:187], v[196:199], v[60:63]
v_mfma_f32_16x16x32_bf16 v[60:63], v[188:191], v[192:195], v[60:63]
v_subrev_u32 v16, 64, v16
v_subrev_u32 v17, 64, v17
s_add_u32 s60, s60, 1
s_cmp_lt_u32 s60, 2
s_cbranch_scc1 Lcl
s_waitcnt lgkmcnt(0)
v_mfma_f32_16x16x32_bf16 v[32:35], v[96:99], v[128:131], v[32:35]
ds_read_b64 v[160:161], v16 offset:3584
v_mfma_f32_16x16x32_bf16 v[36:39], v[96:99], v[132:135], v[36:39]
ds_read_b64 v[162:163], v16 offset:3592
v_mfma_f32_16x16x32_bf16 v[40:43], v[96:99], v[136:139], v[40:43]
ds_read_b128 v[192:195], v17 offset:0
v_mfma_f32_16x16x32_bf16 v[44:47], v[96:99], v[140:143], v[44:47]
ds_read_b64 v[164:165], v16 offset:3072
v_mfma_f32_16x16x32_bf16 v[48:51], v[96:99], v[144:147], v[48:51]
ds_read_b64 v[166:167], v16 offset:3080
v_mfma_f32_16x16x32_bf16 v[52:55], v[96:99], v[148:151], v[52:55]
ds_read_b128 v[196:199], v17 offset:512
v_mfma_f32_16x16x32_bf16 v[56:59], v[96:99], v[152:155], v[56:59]
ds_read_b64 v[168:169], v16 offset:2560
v_mfma_f32_16x16x32_bf16 v[60:63], v[96:99], v[156:159], v[60:63]
ds_read_b64 v[170:171], v16 offset:2568
v_mfma_f32_16x16x32_bf16 v[36:39], v[100:103], v[128:131], v[36:39]
ds_read_b128 v[200:203], v17 offset:1024
v_mfma_f32_16x16x32_bf16 v[40:43], v[100:103], v[132:135], v[40:43]
ds_read_b64 v[172:173], v16 offset:2048
v_mfma_f32_16x16x32_bf16 v[44:47], v[100:103], v[136:139], v[44:47]
ds_read_b64 v[174:175], v16 offset:2056
v_mfma_f32_16x16x32_bf16 v[48:51], v[100:103], v[140:143], v[48:51]
ds_read_b128 v[204:207], v17 offset:1536
v_mfma_f32_16x16x32_bf16 v[52:55], v[100:103], v[144:147], v[52:55]
ds_read_b64 v[176:177], v16 offset:1536
v_mfma_f32_16x16x32_bf16 v[56:59], v[100:103], v[148:151], v[56:59]
ds_read_b64 v[178:179], v16 offset:1544
v_mfma_f32_16x16x32_bf16 v[60:63], v[100:103], v[152:155], v[60:63]
ds_read_b128 v[208:211], v17 offset:2048
v_mfma_f32_16x16x32_bf16 v[40:43], v[104:107], v[128:131], v[40:43]
ds_read_b64 v[180:181], v16 offset:1024
v_mfma_f32_16x16x32_bf16 v[44:47], v[104:107], v[132:135], v[44:47]
ds_read_b64 v[182:183], v16 offset:1032
v_mfma_f32_16x16x32_bf16 v[48:51], v[104:107], v[136:139], v[48:51]
ds_read_b128 v[212:215], v17 offset:2560
v_mfma_f32_16x16x32_bf16 v[52:55], v[104:107], v[140:143], v[52:55]
ds_read_b64 v[184:185], v16 offset:512
v_mfma_f32_16x16x32_bf16 v[56:59], v[104:107], v[144:147], v[56:59]
ds_read_b64 v[186:187], v16 offset:520
v_mfma_f32_16x16x32_bf16 v[60:63], v[104:107], v[148:151], v[60:63]
ds_read_b128 v[216:219], v17 offset:3072
v_mfma_f32_16x16x32_bf16 v[44:47], v[108:111], v[128:131], v[44:47]
ds_read_b64 v[188:189], v16 offset:0
v_mfma_f32_16x16x32_bf16 v[48:51], v[108:111], v[132:135], v[48:51]
ds_read_b64 v[190:191], v16 offset:8
v_mfma_f32_16x16x32_bf16 v[52:55], v[108:111], v[136:139], v[52:55]
ds_read_b128 v[220:223], v17 offset:3584
v_mfma_f32_16x16x32_bf16 v[56:59], v[108:111], v[140:143], v[56:59]
v_mfma_f32_16x16x32_bf16 v[60:63], v[108:111], v[144:147], v[60:63]
v_mfma_f32_16x16x32_bf16 v[48:51], v[112:115], v[128:131], v[48:51]
v_mfma_f32_16x16x32_bf16 v[52:55], v[112:115], v[132:135], v[52:55]
v_mfma_f32_16x16x32_bf16 v[56:59], v[112:115], v[136:139], v[56:59]
v_mfma_f32_16x16x32_bf16 v[60:63], v[112:115], v[140:143], v[60:63]
v_mfma_f32_16x16x32_bf16 v[52:55], v[116:119], v[128:131], v[52:55]
v_mfma_f32_16x16x32_bf16 v[56:59], v[116:119], v[132:135], v[56:59]
v_mfma_f32_16x16x32_bf16 v[60:63], v[116:119], v[136:139], v[60:63]
v_mfma_f32_16x16x32_bf16 v[56:59], v[120:123], v[128:131], v[56:59]
v_mfma_f32_16x16x32_bf16 v[60:63], v[120:123], v[132:135], v[60:63]
v_mfma_f32_16x16x32_bf16 v[60:63], v[124:127], v[128:131], v[60:63]
v_subrev_u32 v16, 64, v16
v_subrev_u32 v17, 64, v17
s_waitcnt lgkmcnt(0)
v_mfma_f32_16x16x32_bf16 v[32:35], v[160:163], v[192:195], v[32:35]
v_mfma_f32_16x16x32_bf16 v[36:39], v[160:163], v[196:199], v[36:39]
v_mfma_f32_16x16x32_bf16 v[40:43], v[160:163], v[200:203], v[40:43]
v_mfma_f32_16x16x32_bf16 v[44:47], v[160:163], v[204:207], v[44:47]
v_mfma_f32_16x16x32_bf16 v[48:51], v[160:163], v[208:211], v[48:51]
v_mfma_f32_16x16x32_bf16 v[52:55], v[160:163], v[212:215], v[52:55]
v_mfma_f32_16x16x32_bf16 v[56:59], v[160:163], v[216:219], v[56:59]
v_mfma_f32_16x16x32_bf16 v[60:63], v[160:163], v[220:223], v[60:63]
v_mfma_f32_16x16x32_bf16 v[36:39], v[164:167], v[192:195], v[36:39]
v_mfma_f32_16x16x32_bf16 v[40:43], v[164:167], v[196:199], v[40:43]
v_mfma_f32_16x16x32_bf16 v[44:47], v[164:167], v[200:203], v[44:47]
v_mfma_f32_16x16x32_bf16 v[48:51], v[164:167], v[204:207], v[48:51]
v_mfma_f32_16x16x32_bf16 v[52:55], v[164:167], v[208:211], v[52:55]
v_mfma_f32_16x16x32_bf16 v[56:59], v[164:167], v[212:215], v[56:59]
v_mfma_f32_16x16x32_bf16 v[60:63], v[164:167], v[216:219], v[60:63]
v_mfma_f32_16x16x32_bf16 v[40:43], v[168:171], v[192:195], v[40:43]
v_mfma_f32_16x16x32_bf16 v[44:47], v[168:171], v[196:199], v[44:47]
v_mfma_f32_16x16x32_bf16 v[48:51], v[168:171], v[200:203], v[48:51]
v_mfma_f32_16x16x32_bf16 v[52:55], v[168:171], v[204:207], v[52:55]
v_mfma_f32_16x16x32_bf16 v[56:59], v[168:171], v[208:211], v[56:59]
v_mfma_f32_16x16x32_bf16 v[60:63], v[168:171], v[212:215], v[60:63]
v_mfma_f32_16x16x32_bf16 v[44:47], v[172:175], v[192:195], v[44:47]
v_mfma_f32_16x16x32_bf16 v[48:51], v[172:175], v[196:199], v[48:51]
v_mfma_f32_16x16x32_bf16 v[52:55], v[172:175], v[200:203], v[52:55]
v_mfma_f32_16x16x32_bf16 v[56:59], v[172:175], v[204:207], v[56:59]
v_mfma_f32_16x16x32_bf16 v[60:63], v[172:175], v[208:211], v[60:63]
v_mfma_f32_16x16x32_bf16 v[48:51], v[176:179], v[192:195], v[48:51]
v_mfma_f32_16x16x32_bf16 v[52:55], v[176:179], v[196:199], v[52:55]
v_mfma_f32_16x16x32_bf16 v[56:59], v[176:179], v[200:203], v[56:59]
v_mfma_f32_16x16x32_bf16 v[60:63], v[176:179], v[204:207], v[60:63]
v_mfma_f32_16x16x32_bf16 v[52:55], v[180:183], v[192:195], v[52:55]
v_mfma_f32_16x16x32_bf16 v[56:59], v[180:183], v[196:199], v[56:59]
v_mfma_f32_16x16x32_bf16 v[60:63], v[180:183], v[200:203], v[60:63]
v_mfma_f32_16x16x32_bf16 v[56:59], v[184:187], v[192:195], v[56:59]
v_mfma_f32_16x16x32_bf16 v[60:63], v[184:187], v[196:199], v[60:63]
v_mfma_f32_16x16x32_bf16 v[60:63], v[188:191], v[192:195], v[60:63]
v_lshlrev_b32 v5, 5, v2
v_lshl_add_u32 v5, v7, 3, v5
s_add_u32 s56, s55, 16777216
s_nop 7
v_cvt_pk_bf16_f32 v32, v32, v33
v_cvt_pk_bf16_f32 v33, v34, v35
buffer_store_dwordx2 v[32:33], v5, s[36:39], s56 offen offset:0 sc1
v_cvt_pk_bf16_f32 v36, v36, v37
v_cvt_pk_bf16_f32 v37, v38, v39
buffer_store_dwordx2 v[36:37], v5, s[36:39], s56 offen offset:512 sc1
v_cvt_pk_bf16_f32 v40, v40, v41
v_cvt_pk_bf16_f32 v41, v42, v43
buffer_store_dwordx2 v[40:41], v5, s[36:39], s56 offen offset:1024 sc1
v_cvt_pk_bf16_f32 v44, v44, v45
v_cvt_pk_bf16_f32 v45, v46, v47
buffer_store_dwordx2 v[44:45], v5, s[36:39], s56 offen offset:1536 sc1
v_cvt_pk_bf16_f32 v48, v48, v49
v_cvt_pk_bf16_f32 v49, v50, v51
buffer_store_dwordx2 v[48:49], v5, s[36:39], s56 offen offset:2048 sc1
v_cvt_pk_bf16_f32 v52, v52, v53
v_cvt_pk_bf16_f32 v53, v54, v55
buffer_store_dwordx2 v[52:53], v5, s[36:39], s56 offen offset:2560 sc1
v_cvt_pk_bf16_f32 v56, v56, v57
v_cvt_pk_bf16_f32 v57, v58, v59
buffer_store_dwordx2 v[56:57], v5, s[36:39], s56 offen offset:3072 sc1
v_cvt_pk_bf16_f32 v60, v60, v61
v_cvt_pk_bf16_f32 v61, v62, v63
buffer_store_dwordx2 v[60:61], v5, s[36:39], s56 offen offset:3584 sc1
s_mov_b64 exec, 1
ds_add_u32 v30, v31 offset:42480
s_mov_b64 exec, -1
v_mov_b32 v30, 84992
s_barrier
ds_read_b64_tr_b16 v[128:129], v228 offset:0
ds_read_b64_tr_b16 v[130:131], v228 offset:512
ds_read_b128 v[96:99], v224 offset:0
ds_read_b128 v[100:103], v224 offset:2048
ds_read_b64_tr_b16 v[132:133], v229 offset:0
ds_read_b64_tr_b16 v[134:135], v229 offset:512
ds_read_b128 v[104:107], v224 offset:4096
ds_read_b128 v[108:111], v224 offset:6144
ds_read_b64_tr_b16 v[136:137], v228 offset:4096
ds_read_b64_tr_b16 v[138:139], v228 offset:4608
ds_read_b128 v[112:115], v225 offset:0
ds_read_b128 v[116:119], v225 offset:2048
ds_read_b64_tr_b16 v[140:141], v229 offset:4096
ds_read_b64_tr_b16 v[142:143], v229 offset:4608
ds_read_b128 v[120:123], v225 offset:4096
ds_read_b128 v[124:127], v225 offset:6144
s_waitcnt lgkmcnt(0)
v_mfma_f32_16x16x32_bf16 v[64:67], v[128:131], v[96:99], 0
v_mfma_f32_16x16x32_bf16 v[68:71], v[128:131], v[100:103], 0
s_barrier
ds_read_b64_tr_b16 v[176:177], v228 offset:24576
ds_read_b64_tr_b16 v[178:179], v228 offset:25088
v_mfma_f32_16x16x32_bf16 v[72:75], v[128:131], v[104:107], 0
ds_read_b128 v[144:147], v224 offset:24576
ds_read_b128 v[148:151], v224 offset:26624
v_mfma_f32_16x16x32_bf16 v[76:79], v[128:131], v[108:111], 0
ds_read_b64_tr_b16 v[180:181], v229 offset:24576
ds_read_b64_tr_b16 v[182:183], v229 offset:25088
v_mfma_f32_16x16x32_bf16 v[80:83], v[132:135], v[96:99], 0
ds_read_b128 v[152:155], v224 offset:28672
ds_read_b128 v[156:159], v224 offset:30720
v_mfma_f32_16x16x32_bf16 v[84:87], v[132:135], v[100:103], 0
ds_read_b64_tr_b16 v[184:185], v228 offset:28672
ds_read_b64_tr_b16 v[186:187], v228 offset:29184
v_mfma_f32_16x16x32_bf16 v[88:91], v[132:135], v[104:107], 0
ds_read_b128 v[160:163], v225 offset:24576
ds_read_b128 v[164:167], v225 offset:26624
v_mfma_f32_16x16x32_bf16 v[92:95], v[132:135], v[108:111], 0
ds_read_b64_tr_b16 v[188:189], v229 offset:28672
ds_read_b64_tr_b16 v[190:191], v229 offset:29184
v_mfma_f32_16x16x32_bf16 v[64:67], v[136:139], v[112:115], v[64:67]
ds_read_b128 v[168:171], v225 offset:28672
ds_read_b128 v[172:175], v225 offset:30720
v_mfma_f32_16x16x32_bf16 v[68:71], v[136:139], v[116:119], v[68:71]
v_mfma_f32_16x16x32_bf16 v[72:75], v[136:139], v[120:123], v[72:75]
v_mfma_f32_16x16x32_bf16 v[76:79], v[136:139], v[124:127], v[76:79]
v_mfma_f32_16x16x32_bf16 v[80:83], v[140:143], v[112:115], v[80:83]
v_mfma_f32_16x16x32_bf16 v[84:87], v[140:143], v[116:119], v[84:87]
v_mfma_f32_16x16x32_bf16 v[88:91], v[140:143], v[120:123], v[88:91]
v_mfma_f32_16x16x32_bf16 v[92:95], v[140:143], v[124:127], v[92:95]
s_waitcnt lgkmcnt(0)
v_mfma_f32_16x16x32_bf16 v[64:67], v[176:179], v[144:147], v[64:67]
v_mfma_f32_16x16x32_bf16 v[68:71], v[176:179], v[148:151], v[68:71]
s_barrier
ds_read_b64_tr_b16 v[128:129], v228 offset:49152
ds_read_b64_tr_b16 v[130:131], v228 offset:49664
v_mfma_f32_16x16x32_bf16 v[72:75], v[176:179], v[152:155], v[72:75]
ds_read_b128 v[96:99], v224 offset:49152
ds_read_b128 v[100:103], v224 offset:51200
v_mfma_f32_16x16x32_bf16 v[76:79], v[176:179], v[156:159], v[76:79]
ds_read_b64_tr_b16 v[132:133], v229 offset:49152
ds_read_b64_tr_b16 v[134:135], v229 offset:49664
v_mfma_f32_16x16x32_bf16 v[80:83], v[180:183], v[144:147], v[80:83]
ds_read_b128 v[104:107], v224 offset:53248
ds_read_b128 v[108:111], v224 offset:55296
v_mfma_f32_16x16x32_bf16 v[84:87], v[180:183], v[148:151], v[84:87]
ds_read_b64_tr_b16 v[136:137], v228 offset:53248
ds_read_b64_tr_b16 v[138:139], v228 offset:53760
v_mfma_f32_16x16x32_bf16 v[88:91], v[180:183], v[152:155], v[88:91]
ds_read_b128 v[112:115], v225 offset:49152
ds_read_b128 v[116:119], v225 offset:51200
v_mfma_f32_16x16x32_bf16 v[92:95], v[180:183], v[156:159], v[92:95]
ds_read_b64_tr_b16 v[140:141], v229 offset:53248
ds_read_b64_tr_b16 v[142:143], v229 offset:53760
v_mfma_f32_16x16x32_bf16 v[64:67], v[184:187], v[160:163], v[64:67]
ds_read_b128 v[120:123], v225 offset:53248
ds_read_b128 v[124:127], v225 offset:55296
v_mfma_f32_16x16x32_bf16 v[68:71], v[184:187], v[164:167], v[68:71]
v_mfma_f32_16x16x32_bf16 v[72:75], v[184:187], v[168:171], v[72:75]
v_mfma_f32_16x16x32_bf16 v[76:79], v[184:187], v[172:175], v[76:79]
v_mfma_f32_16x16x32_bf16 v[80:83], v[188:191], v[160:163], v[80:83]
v_mfma_f32_16x16x32_bf16 v[84:87], v[188:191], v[164:167], v[84:87]
v_mfma_f32_16x16x32_bf16 v[88:91], v[188:191], v[168:171], v[88:91]
v_mfma_f32_16x16x32_bf16 v[92:95], v[188:191], v[172:175], v[92:95]
s_waitcnt lgkmcnt(0)
v_mfma_f32_16x16x32_bf16 v[64:67], v[128:131], v[96:99], v[64:67]
v_mfma_f32_16x16x32_bf16 v[68:71], v[128:131], v[100:103], v[68:71]
s_barrier
ds_read_b64_tr_b16 v[176:177], v230 offset:0
ds_read_b64_tr_b16 v[178:179], v230 offset:512
v_mfma_f32_16x16x32_bf16 v[72:75], v[128:131], v[104:107], v[72:75]
ds_read_b128 v[144:147], v226 offset:0
ds_read_b128 v[148:151], v226 offset:2048
v_mfma_f32_16x16x32_bf16 v[76:79], v[128:131], v[108:111], v[76:79]
ds_read_b64_tr_b16 v[180:181], v231 offset:0
ds_read_b64_tr_b16 v[182:183], v231 offset:512
v_mfma_f32_16x16x32_bf16 v[80:83], v[132:135], v[96:99], v[80:83]
ds_read_b128 v[152:155], v226 offset:4096
ds_read_b128 v[156:159], v226 offset:6144
v_mfma_f32_16x16x32_bf16 v[84:87], v[132:135], v[100:103], v[84:87]
ds_read_b64_tr_b16 v[184:185], v230 offset:4096
ds_read_b64_tr_b16 v[186:187], v230 offset:4608
v_mfma_f32_16x16x32_bf16 v[88:91], v[132:135], v[104:107], v[88:91]
ds_read_b128 v[160:163], v227 offset:0
ds_read_b128 v[164:167], v227 offset:2048
v_mfma_f32_16x16x32_bf16 v[92:95], v[132:135], v[108:111], v[92:95]
ds_read_b64_tr_b16 v[188:189], v231 offset:4096
ds_read_b64_tr_b16 v[190:191], v231 offset:4608
v_mfma_f32_16x16x32_bf16 v[64:67], v[136:139], v[112:115], v[64:67]
ds_read_b128 v[168:171], v227 offset:4096
ds_read_b128 v[172:175], v227 offset:6144
v_mfma_f32_16x16x32_bf16 v[68:71], v[136:139], v[116:119], v[68:71]
v_mfma_f32_16x16x32_bf16 v[72:75], v[136:139], v[120:123], v[72:75]
v_mfma_f32_16x16x32_bf16 v[76:79], v[136:139], v[124:127], v[76:79]
v_mfma_f32_16x16x32_bf16 v[80:83], v[140:143], v[112:115], v[80:83]
v_mfma_f32_16x16x32_bf16 v[84:87], v[140:143], v[116:119], v[84:87]
v_mfma_f32_16x16x32_bf16 v[88:91], v[140:143], v[120:123], v[88:91]
v_mfma_f32_16x16x32_bf16 v[92:95], v[140:143], v[124:127], v[92:95]
s_waitcnt lgkmcnt(0)
v_mfma_f32_16x16x32_bf16 v[64:67], v[176:179], v[144:147], v[64:67]
v_mfma_f32_16x16x32_bf16 v[68:71], v[176:179], v[148:151], v[68:71]
s_barrier
ds_read_b64_tr_b16 v[128:129], v230 offset:24576
ds_read_b64_tr_b16 v[130:131], v230 offset:25088
v_mfma_f32_16x16x32_bf16 v[72:75], v[176:179], v[152:155], v[72:75]
ds_read_b128 v[96:99], v226 offset:24576
ds_read_b128 v[100:103], v226 offset:26624
v_mfma_f32_16x16x32_bf16 v[76:79], v[176:179], v[156:159], v[76:79]
ds_read_b64_tr_b16 v[132:133], v231 offset:24576
ds_read_b64_tr_b16 v[134:135], v231 offset:25088
v_mfma_f32_16x16x32_bf16 v[80:83], v[180:183], v[144:147], v[80:83]
ds_read_b128 v[104:107], v226 offset:28672
ds_read_b128 v[108:111], v226 offset:30720
v_mfma_f32_16x16x32_bf16 v[84:87], v[180:183], v[148:151], v[84:87]
ds_read_b64_tr_b16 v[136:137], v230 offset:28672
ds_read_b64_tr_b16 v[138:139], v230 offset:29184
v_mfma_f32_16x16x32_bf16 v[88:91], v[180:183], v[152:155], v[88:91]
ds_read_b128 v[112:115], v227 offset:24576
ds_read_b128 v[116:119], v227 offset:26624
v_mfma_f32_16x16x32_bf16 v[92:95], v[180:183], v[156:159], v[92:95]
ds_read_b64_tr_b16 v[140:141], v231 offset:28672
ds_read_b64_tr_b16 v[142:143], v231 offset:29184
v_mfma_f32_16x16x32_bf16 v[64:67], v[184:187], v[160:163], v[64:67]
ds_read_b128 v[120:123], v227 offset:28672
ds_read_b128 v[124:127], v227 offset:30720
v_mfma_f32_16x16x32_bf16 v[68:71], v[184:187], v[164:167], v[68:71]
v_mfma_f32_16x16x32_bf16 v[72:75], v[184:187], v[168:171], v[72:75]
v_mfma_f32_16x16x32_bf16 v[76:79], v[184:187], v[172:175], v[76:79]
v_mfma_f32_16x16x32_bf16 v[80:83], v[188:191], v[160:163], v[80:83]
v_mfma_f32_16x16x32_bf16 v[84:87], v[188:191], v[164:167], v[84:87]
v_mfma_f32_16x16x32_bf16 v[88:91], v[188:191], v[168:171], v[88:91]
v_mfma_f32_16x16x32_bf16 v[92:95], v[188:191], v[172:175], v[92:95]
s_waitcnt lgkmcnt(0)
s_waitcnt vmcnt(0)
s_lshr_b32 s65, s53, 2
s_lshl_b32 s65, s65, 7
s_add_u32 s65, s65, 12156928
v_mov_b32 v28, s65
s_mov_b64 exec, 1
ds_add_rtn_u32 v29, v30, v31 offset:0
s_waitcnt lgkmcnt(0)
v_readfirstlane_b32 s60, v29
s_cmp_eq_u32 s60, 3
s_cbranch_scc0 Lcl198
buffer_store_dword v31, v28, s[36:39], 0 offen sc1
Lcl198:
s_mov_b64 exec, -1
s_nop 4
v_mfma_f32_16x16x32_bf16 v[64:67], v[128:131], v[96:99], v[64:67]
v_mfma_f32_16x16x32_bf16 v[68:71], v[128:131], v[100:103], v[68:71]
s_barrier
ds_read_b64_tr_b16 v[176:177], v230 offset:49152
ds_read_b64_tr_b16 v[178:179], v230 offset:49664
v_mfma_f32_16x16x32_bf16 v[72:75], v[128:131], v[104:107], v[72:75]
ds_read_b128 v[144:147], v226 offset:49152
ds_read_b128 v[148:151], v226 offset:51200
v_mfma_f32_16x16x32_bf16 v[76:79], v[128:131], v[108:111], v[76:79]
ds_read_b64_tr_b16 v[180:181], v231 offset:49152
ds_read_b64_tr_b16 v[182:183], v231 offset:49664
v_mfma_f32_16x16x32_bf16 v[80:83], v[132:135], v[96:99], v[80:83]
ds_read_b128 v[152:155], v226 offset:53248
ds_read_b128 v[156:159], v226 offset:55296
v_mfma_f32_16x16x32_bf16 v[84:87], v[132:135], v[100:103], v[84:87]
ds_read_b64_tr_b16 v[184:185], v230 offset:53248
ds_read_b64_tr_b16 v[186:187], v230 offset:53760
v_mfma_f32_16x16x32_bf16 v[88:91], v[132:135], v[104:107], v[88:91]
ds_read_b128 v[160:163], v227 offset:49152
ds_read_b128 v[164:167], v227 offset:51200
v_mfma_f32_16x16x32_bf16 v[92:95], v[132:135], v[108:111], v[92:95]
ds_read_b64_tr_b16 v[188:189], v231 offset:53248
ds_read_b64_tr_b16 v[190:191], v231 offset:53760
v_mfma_f32_16x16x32_bf16 v[64:67], v[136:139], v[112:115], v[64:67]
ds_read_b128 v[168:171], v227 offset:53248
ds_read_b128 v[172:175], v227 offset:55296
v_mfma_f32_16x16x32_bf16 v[68:71], v[136:139], v[116:119], v[68:71]
v_mfma_f32_16x16x32_bf16 v[72:75], v[136:139], v[120:123], v[72:75]
v_mfma_f32_16x16x32_bf16 v[76:79], v[136:139], v[124:127], v[76:79]
v_mfma_f32_16x16x32_bf16 v[80:83], v[140:143], v[112:115], v[80:83]
v_mfma_f32_16x16x32_bf16 v[84:87], v[140:143], v[116:119], v[84:87]
v_mfma_f32_16x16x32_bf16 v[88:91], v[140:143], v[120:123], v[88:91]
v_mfma_f32_16x16x32_bf16 v[92:95], v[140:143], v[124:127], v[92:95]
s_waitcnt lgkmcnt(0)
v_mfma_f32_16x16x32_bf16 v[64:67], v[176:179], v[144:147], v[64:67]
v_mfma_f32_16x16x32_bf16 v[68:71], v[176:179], v[148:151], v[68:71]
s_barrier
ds_read_b64_tr_b16 v[128:129], v228 offset:0
ds_read_b64_tr_b16 v[130:131], v228 offset:512
v_mfma_f32_16x16x32_bf16 v[72:75], v[176:179], v[152:155], v[72:75]
ds_read_b128 v[96:99], v224 offset:0
ds_read_b128 v[100:103], v224 offset:2048
v_mfma_f32_16x16x32_bf16 v[76:79], v[176:179], v[156:159], v[76:79]
ds_read_b64_tr_b16 v[132:133], v229 offset:0
ds_read_b64_tr_b16 v[134:135], v229 offset:512
v_mfma_f32_16x16x32_bf16 v[80:83], v[180:183], v[144:147], v[80:83]
ds_read_b128 v[104:107], v224 offset:4096
ds_read_b128 v[108:111], v224 offset:6144
v_mfma_f32_16x16x32_bf16 v[84:87], v[180:183], v[148:151], v[84:87]
ds_read_b64_tr_b16 v[136:137], v228 offset:4096
ds_read_b64_tr_b16 v[138:139], v228 offset:4608
v_mfma_f32_16x16x32_bf16 v[88:91], v[180:183], v[152:155], v[88:91]
ds_read_b128 v[112:115], v225 offset:0
ds_read_b128 v[116:119], v225 offset:2048
v_mfma_f32_16x16x32_bf16 v[92:95], v[180:183], v[156:159], v[92:95]
ds_read_b64_tr_b16 v[140:141], v229 offset:4096
ds_read_b64_tr_b16 v[142:143], v229 offset:4608
v_mfma_f32_16x16x32_bf16 v[64:67], v[184:187], v[160:163], v[64:67]
ds_read_b128 v[120:123], v225 offset:4096
ds_read_b128 v[124:127], v225 offset:6144
v_mfma_f32_16x16x32_bf16 v[68:71], v[184:187], v[164:167], v[68:71]
v_lshlrev_b32 v192, 16, v232
v_and_b32 v193, 0xffff0000, v232
v_lshlrev_b32 v194, 16, v233
v_mfma_f32_16x16x32_bf16 v[72:75], v[184:187], v[168:171], v[72:75]
v_and_b32 v195, 0xffff0000, v233
v_mfma_f32_16x16x32_bf16 v[76:79], v[184:187], v[172:175], v[76:79]
v_mfma_f32_16x16x32_bf16 v[80:83], v[188:191], v[160:163], v[80:83]
v_mfma_f32_16x16x32_bf16 v[84:87], v[188:191], v[164:167], v[84:87]
v_mfma_f32_16x16x32_bf16 v[88:91], v[188:191], v[168:171], v[88:91]
v_mfma_f32_16x16x32_bf16 v[92:95], v[188:191], v[172:175], v[92:95]
s_waitcnt lgkmcnt(0)
v_mfma_f32_16x16x32_bf16 v[64:67], v[128:131], v[96:99], v[64:67]
v_mfma_f32_16x16x32_bf16 v[68:71], v[128:131], v[100:103], v[68:71]
s_barrier
ds_read_b64_tr_b16 v[176:177], v228 offset:24576
ds_read_b64_tr_b16 v[178:179], v228 offset:25088
v_mfma_f32_16x16x32_bf16 v[72:75], v[128:131], v[104:107], v[72:75]
ds_read_b128 v[144:147], v224 offset:24576
ds_read_b128 v[148:151], v224 offset:26624
v_mfma_f32_16x16x32_bf16 v[76:79], v[128:131], v[108:111], v[76:79]
ds_read_b64_tr_b16 v[180:181], v229 offset:24576
ds_read_b64_tr_b16 v[182:183], v229 offset:25088
v_mfma_f32_16x16x32_bf16 v[80:83], v[132:135], v[96:99], v[80:83]
ds_read_b128 v[152:155], v224 offset:28672
ds_read_b128 v[156:159], v224 offset:30720
v_mfma_f32_16x16x32_bf16 v[84:87], v[132:135], v[100:103], v[84:87]
ds_read_b64_tr_b16 v[184:185], v228 offset:28672
ds_read_b64_tr_b16 v[186:187], v228 offset:29184
v_mfma_f32_16x16x32_bf16 v[88:91], v[132:135], v[104:107], v[88:91]
ds_read_b128 v[160:163], v225 offset:24576
ds_read_b128 v[164:167], v225 offset:26624
v_mfma_f32_16x16x32_bf16 v[92:95], v[132:135], v[108:111], v[92:95]
ds_read_b64_tr_b16 v[188:189], v229 offset:28672
ds_read_b64_tr_b16 v[190:191], v229 offset:29184
v_mfma_f32_16x16x32_bf16 v[64:67], v[136:139], v[112:115], v[64:67]
ds_read_b128 v[168:171], v225 offset:28672
ds_read_b128 v[172:175], v225 offset:30720
v_mfma_f32_16x16x32_bf16 v[68:71], v[136:139], v[116:119], v[68:71]
v_lshlrev_b32 v196, 16, v234
v_and_b32 v197, 0xffff0000, v234
v_lshlrev_b32 v198, 16, v235
v_mfma_f32_16x16x32_bf16 v[72:75], v[136:139], v[120:123], v[72:75]
v_and_b32 v199, 0xffff0000, v235
v_mfma_f32_16x16x32_bf16 v[76:79], v[136:139], v[124:127], v[76:79]
v_mfma_f32_16x16x32_bf16 v[80:83], v[140:143], v[112:115], v[80:83]
v_mfma_f32_16x16x32_bf16 v[84:87], v[140:143], v[116:119], v[84:87]
v_mfma_f32_16x16x32_bf16 v[88:91], v[140:143], v[120:123], v[88:91]
v_mfma_f32_16x16x32_bf16 v[92:95], v[140:143], v[124:127], v[92:95]
s_waitcnt lgkmcnt(0)
v_mfma_f32_16x16x32_bf16 v[64:67], v[176:179], v[144:147], v[64:67]
v_mfma_f32_16x16x32_bf16 v[68:71], v[176:179], v[148:151], v[68:71]
s_barrier
ds_read_b64_tr_b16 v[128:129], v228 offset:49152
ds_read_b64_tr_b16 v[130:131], v228 offset:49664
v_mfma_f32_16x16x32_bf16 v[72:75], v[176:179], v[152:155], v[72:75]
ds_read_b128 v[96:99], v224 offset:49152
ds_read_b128 v[100:103], v224 offset:51200
v_mfma_f32_16x16x32_bf16 v[76:79], v[176:179], v[156:159], v[76:79]
ds_read_b64_tr_b16 v[132:133], v229 offset:49152
ds_read_b64_tr_b16 v[134:135], v229 offset:49664
v_mfma_f32_16x16x32_bf16 v[80:83], v[180:183], v[144:147], v[80:83]
ds_read_b128 v[104:107], v224 offset:53248
ds_read_b128 v[108:111], v224 offset:55296
v_mfma_f32_16x16x32_bf16 v[84:87], v[180:183], v[148:151], v[84:87]
ds_read_b64_tr_b16 v[136:137], v228 offset:53248
ds_read_b64_tr_b16 v[138:139], v228 offset:53760
v_mfma_f32_16x16x32_bf16 v[88:91], v[180:183], v[152:155], v[88:91]
ds_read_b128 v[112:115], v225 offset:49152
ds_read_b128 v[116:119], v225 offset:51200
v_mfma_f32_16x16x32_bf16 v[92:95], v[180:183], v[156:159], v[92:95]
ds_read_b64_tr_b16 v[140:141], v229 offset:53248
ds_read_b64_tr_b16 v[142:143], v229 offset:53760
v_mfma_f32_16x16x32_bf16 v[64:67], v[184:187], v[160:163], v[64:67]
ds_read_b128 v[120:123], v225 offset:53248
ds_read_b128 v[124:127], v225 offset:55296
v_mfma_f32_16x16x32_bf16 v[68:71], v[184:187], v[164:167], v[68:71]
v_lshlrev_b32 v200, 16, v236
v_and_b32 v201, 0xffff0000, v236
v_lshlrev_b32 v202, 16, v237
v_mfma_f32_16x16x32_bf16 v[72:75], v[184:187], v[168:171], v[72:75]
v_and_b32 v203, 0xffff0000, v237
v_mfma_f32_16x16x32_bf16 v[76:79], v[184:187], v[172:175], v[76:79]
v_mfma_f32_16x16x32_bf16 v[80:83], v[188:191], v[160:163], v[80:83]
v_mfma_f32_16x16x32_bf16 v[84:87], v[188:191], v[164:167], v[84:87]
v_mfma_f32_16x16x32_bf16 v[88:91], v[188:191], v[168:171], v[88:91]
v_mfma_f32_16x16x32_bf16 v[92:95], v[188:191], v[172:175], v[92:95]
s_waitcnt lgkmcnt(0)
v_mfma_f32_16x16x32_bf16 v[64:67], v[128:131], v[96:99], v[64:67]
v_mfma_f32_16x16x32_bf16 v[68:71], v[128:131], v[100:103], v[68:71]
s_barrier
ds_read_b64_tr_b16 v[176:177], v230 offset:0
ds_read_b64_tr_b16 v[178:179], v230 offset:512
v_mfma_f32_16x16x32_bf16 v[72:75], v[128:131], v[104:107], v[72:75]
ds_read_b128 v[144:147], v226 offset:0
ds_read_b128 v[148:151], v226 offset:2048
v_mfma_f32_16x16x32_bf16 v[76:79], v[128:131], v[108:111], v[76:79]
ds_read_b64_tr_b16 v[180:181], v231 offset:0
ds_read_b64_tr_b16 v[182:183], v231 offset:512
v_mfma_f32_16x16x32_bf16 v[80:83], v[132:135], v[96:99], v[80:83]
ds_read_b128 v[152:155], v226 offset:4096
ds_read_b128 v[156:159], v226 offset:6144
v_mfma_f32_16x16x32_bf16 v[84:87], v[132:135], v[100:103], v[84:87]
ds_read_b64_tr_b16 v[184:185], v230 offset:4096
ds_read_b64_tr_b16 v[186:187], v230 offset:4608
v_mfma_f32_16x16x32_bf16 v[88:91], v[132:135], v[104:107], v[88:91]
ds_read_b128 v[160:163], v227 offset:0
ds_read_b128 v[164:167], v227 offset:2048
v_mfma_f32_16x16x32_bf16 v[92:95], v[132:135], v[108:111], v[92:95]
ds_read_b64_tr_b16 v[188:189], v231 offset:4096
ds_read_b64_tr_b16 v[190:191], v231 offset:4608
v_mfma_f32_16x16x32_bf16 v[64:67], v[136:139], v[112:115], v[64:67]
ds_read_b128 v[168:171], v227 offset:4096
ds_read_b128 v[172:175], v227 offset:6144
v_mfma_f32_16x16x32_bf16 v[68:71], v[136:139], v[116:119], v[68:71]
v_lshlrev_b32 v204, 16, v238
v_and_b32 v205, 0xffff0000, v238
v_lshlrev_b32 v206, 16, v239
v_mfma_f32_16x16x32_bf16 v[72:75], v[136:139], v[120:123], v[72:75]
v_and_b32 v207, 0xffff0000, v239
v_mfma_f32_16x16x32_bf16 v[76:79], v[136:139], v[124:127], v[76:79]
v_mfma_f32_16x16x32_bf16 v[80:83], v[140:143], v[112:115], v[80:83]
v_mfma_f32_16x16x32_bf16 v[84:87], v[140:143], v[116:119], v[84:87]
v_mfma_f32_16x16x32_bf16 v[88:91], v[140:143], v[120:123], v[88:91]
v_mfma_f32_16x16x32_bf16 v[92:95], v[140:143], v[124:127], v[92:95]
s_waitcnt lgkmcnt(0)
v_mfma_f32_16x16x32_bf16 v[64:67], v[176:179], v[144:147], v[64:67]
v_mfma_f32_16x16x32_bf16 v[68:71], v[176:179], v[148:151], v[68:71]
s_barrier
ds_read_b64_tr_b16 v[128:129], v230 offset:24576
ds_read_b64_tr_b16 v[130:131], v230 offset:25088
v_mfma_f32_16x16x32_bf16 v[72:75], v[176:179], v[152:155], v[72:75]
ds_read_b128 v[96:99], v226 offset:24576
ds_read_b128 v[100:103], v226 offset:26624
v_mfma_f32_16x16x32_bf16 v[76:79], v[176:179], v[156:159], v[76:79]
ds_read_b64_tr_b16 v[132:133], v231 offset:24576
ds_read_b64_tr_b16 v[134:135], v231 offset:25088
v_mfma_f32_16x16x32_bf16 v[80:83], v[180:183], v[144:147], v[80:83]
ds_read_b128 v[104:107], v226 offset:28672
ds_read_b128 v[108:111], v226 offset:30720
v_mfma_f32_16x16x32_bf16 v[84:87], v[180:183], v[148:151], v[84:87]
ds_read_b64_tr_b16 v[136:137], v230 offset:28672
ds_read_b64_tr_b16 v[138:139], v230 offset:29184
v_mfma_f32_16x16x32_bf16 v[88:91], v[180:183], v[152:155], v[88:91]
ds_read_b128 v[112:115], v227 offset:24576
ds_read_b128 v[116:119], v227 offset:26624
v_mfma_f32_16x16x32_bf16 v[92:95], v[180:183], v[156:159], v[92:95]
ds_read_b64_tr_b16 v[140:141], v231 offset:28672
ds_read_b64_tr_b16 v[142:143], v231 offset:29184
v_mfma_f32_16x16x32_bf16 v[64:67], v[184:187], v[160:163], v[64:67]
ds_read_b128 v[120:123], v227 offset:28672
ds_read_b128 v[124:127], v227 offset:30720
v_mfma_f32_16x16x32_bf16 v[68:71], v[184:187], v[164:167], v[68:71]
v_lshlrev_b32 v208, 16, v240
v_and_b32 v209, 0xffff0000, v240
v_lshlrev_b32 v210, 16, v241
v_mfma_f32_16x16x32_bf16 v[72:75], v[184:187], v[168:171], v[72:75]
v_and_b32 v211, 0xffff0000, v241
v_mfma_f32_16x16x32_bf16 v[76:79], v[184:187], v[172:175], v[76:79]
v_mfma_f32_16x16x32_bf16 v[80:83], v[188:191], v[160:163], v[80:83]
v_mfma_f32_16x16x32_bf16 v[84:87], v[188:191], v[164:167], v[84:87]
v_mfma_f32_16x16x32_bf16 v[88:91], v[188:191], v[168:171], v[88:91]
v_mfma_f32_16x16x32_bf16 v[92:95], v[188:191], v[172:175], v[92:95]
s_waitcnt lgkmcnt(0)
v_mfma_f32_16x16x32_bf16 v[64:67], v[128:131], v[96:99], v[64:67]
v_mfma_f32_16x16x32_bf16 v[68:71], v[128:131], v[100:103], v[68:71]
s_barrier
ds_read_b64_tr_b16 v[176:177], v230 offset:49152
ds_read_b64_tr_b16 v[178:179], v230 offset:49664
v_mfma_f32_16x16x32_bf16 v[72:75], v[128:131], v[104:107], v[72:75]
ds_read_b128 v[144:147], v226 offset:49152
ds_read_b128 v[148:151], v226 offset:51200
v_mfma_f32_16x16x32_bf16 v[76:79], v[128:131], v[108:111], v[76:79]
ds_read_b64_tr_b16 v[180:181], v231 offset:49152
ds_read_b64_tr_b16 v[182:183], v231 offset:49664
v_mfma_f32_16x16x32_bf16 v[80:83], v[132:135], v[96:99], v[80:83]
ds_read_b128 v[152:155], v226 offset:53248
ds_read_b128 v[156:159], v226 offset:55296
v_mfma_f32_16x16x32_bf16 v[84:87], v[132:135], v[100:103], v[84:87]
ds_read_b64_tr_b16 v[184:185], v230 offset:53248
ds_read_b64_tr_b16 v[186:187], v230 offset:53760
v_mfma_f32_16x16x32_bf16 v[88:91], v[132:135], v[104:107], v[88:91]
ds_read_b128 v[160:163], v227 offset:49152
ds_read_b128 v[164:167], v227 offset:51200
v_mfma_f32_16x16x32_bf16 v[92:95], v[132:135], v[108:111], v[92:95]
ds_read_b64_tr_b16 v[188:189], v231 offset:53248
ds_read_b64_tr_b16 v[190:191], v231 offset:53760
v_mfma_f32_16x16x32_bf16 v[64:67], v[136:139], v[112:115], v[64:67]
ds_read_b128 v[168:171], v227 offset:53248
ds_read_b128 v[172:175], v227 offset:55296
v_mfma_f32_16x16x32_bf16 v[68:71], v[136:139], v[116:119], v[68:71]
v_lshlrev_b32 v212, 16, v242
v_and_b32 v213, 0xffff0000, v242
v_lshlrev_b32 v214, 16, v243
v_mfma_f32_16x16x32_bf16 v[72:75], v[136:139], v[120:123], v[72:75]
v_and_b32 v215, 0xffff0000, v243
v_mfma_f32_16x16x32_bf16 v[76:79], v[136:139], v[124:127], v[76:79]
v_mfma_f32_16x16x32_bf16 v[80:83], v[140:143], v[112:115], v[80:83]
v_mfma_f32_16x16x32_bf16 v[84:87], v[140:143], v[116:119], v[84:87]
v_mfma_f32_16x16x32_bf16 v[88:91], v[140:143], v[120:123], v[88:91]
v_mfma_f32_16x16x32_bf16 v[92:95], v[140:143], v[124:127], v[92:95]
s_waitcnt lgkmcnt(0)
s_mov_b32 s61, 11534336
buffer_load_dword v32, v23, s[36:39], s61 offen offset:0 sc1
buffer_load_dword v36, v23, s[36:39], s61 offen offset:64 sc1
buffer_load_dword v40, v23, s[36:39], s61 offen offset:128 sc1
buffer_load_dword v44, v23, s[36:39], s61 offen offset:192 sc1
v_mfma_f32_16x16x32_bf16 v[64:67], v[176:179], v[144:147], v[64:67]
v_mfma_f32_16x16x32_bf16 v[68:71], v[176:179], v[148:151], v[68:71]
s_barrier
ds_read_b64_tr_b16 v[128:129], v228 offset:0
ds_read_b64_tr_b16 v[130:131], v228 offset:512
v_mfma_f32_16x16x32_bf16 v[72:75], v[176:179], v[152:155], v[72:75]
ds_read_b128 v[96:99], v224 offset:0
ds_read_b128 v[100:103], v224 offset:2048
v_mfma_f32_16x16x32_bf16 v[76:79], v[176:179], v[156:159], v[76:79]
ds_read_b64_tr_b16 v[132:133], v229 offset:0
ds_read_b64_tr_b16 v[134:135], v229 offset:512
v_mfma_f32_16x16x32_bf16 v[80:83], v[180:183], v[144:147], v[80:83]
ds_read_b128 v[104:107], v224 offset:4096
ds_read_b128 v[108:111], v224 offset:6144
v_mfma_f32_16x16x32_bf16 v[84:87], v[180:183], v[148:151], v[84:87]
ds_read_b64_tr_b16 v[136:137], v228 offset:4096
ds_read_b64_tr_b16 v[138:139], v228 offset:4608
v_mfma_f32_16x16x32_bf16 v[88:91], v[180:183], v[152:155], v[88:91]
ds_read_b128 v[112:115], v225 offset:0
ds_read_b128 v[116:119], v225 offset:2048
v_mfma_f32_16x16x32_bf16 v[92:95], v[180:183], v[156:159], v[92:95]
ds_read_b64_tr_b16 v[140:141], v229 offset:4096
ds_read_b64_tr_b16 v[142:143], v229 offset:4608
v_mfma_f32_16x16x32_bf16 v[64:67], v[184:187], v[160:163], v[64:67]
ds_read_b128 v[120:123], v225 offset:4096
ds_read_b128 v[124:127], v225 offset:6144
v_mfma_f32_16x16x32_bf16 v[68:71], v[184:187], v[164:167], v[68:71]
v_lshlrev_b32 v216, 16, v244
v_and_b32 v217, 0xffff0000, v244
v_lshlrev_b32 v218, 16, v245
v_mfma_f32_16x16x32_bf16 v[72:75], v[184:187], v[168:171], v[72:75]
v_and_b32 v219, 0xffff0000, v245
v_mfma_f32_16x16x32_bf16 v[76:79], v[184:187], v[172:175], v[76:79]
v_mfma_f32_16x16x32_bf16 v[80:83], v[188:191], v[160:163], v[80:83]
v_mfma_f32_16x16x32_bf16 v[84:87], v[188:191], v[164:167], v[84:87]
v_mfma_f32_16x16x32_bf16 v[88:91], v[188:191], v[168:171], v[88:91]
v_mfma_f32_16x16x32_bf16 v[92:95], v[188:191], v[172:175], v[92:95]
s_waitcnt lgkmcnt(0)
v_mfma_f32_16x16x32_bf16 v[64:67], v[128:131], v[96:99], v[64:67]
v_mfma_f32_16x16x32_bf16 v[68:71], v[128:131], v[100:103], v[68:71]
s_barrier
ds_read_b64_tr_b16 v[176:177], v228 offset:24576
ds_read_b64_tr_b16 v[178:179], v228 offset:25088
v_mfma_f32_16x16x32_bf16 v[72:75], v[128:131], v[104:107], v[72:75]
ds_read_b128 v[144:147], v224 offset:24576
ds_read_b128 v[148:151], v224 offset:26624
v_mfma_f32_16x16x32_bf16 v[76:79], v[128:131], v[108:111], v[76:79]
ds_read_b64_tr_b16 v[180:181], v229 offset:24576
ds_read_b64_tr_b16 v[182:183], v229 offset:25088
v_mfma_f32_16x16x32_bf16 v[80:83], v[132:135], v[96:99], v[80:83]
ds_read_b128 v[152:155], v224 offset:28672
ds_read_b128 v[156:159], v224 offset:30720
v_mfma_f32_16x16x32_bf16 v[84:87], v[132:135], v[100:103], v[84:87]
ds_read_b64_tr_b16 v[184:185], v228 offset:28672
ds_read_b64_tr_b16 v[186:187], v228 offset:29184
v_mfma_f32_16x16x32_bf16 v[88:91], v[132:135], v[104:107], v[88:91]
ds_read_b128 v[160:163], v225 offset:24576
ds_read_b128 v[164:167], v225 offset:26624
v_mfma_f32_16x16x32_bf16 v[92:95], v[132:135], v[108:111], v[92:95]
ds_read_b64_tr_b16 v[188:189], v229 offset:28672
ds_read_b64_tr_b16 v[190:191], v229 offset:29184
v_mfma_f32_16x16x32_bf16 v[64:67], v[136:139], v[112:115], v[64:67]
ds_read_b128 v[168:171], v225 offset:28672
ds_read_b128 v[172:175], v225 offset:30720
v_mfma_f32_16x16x32_bf16 v[68:71], v[136:139], v[116:119], v[68:71]
v_lshlrev_b32 v220, 16, v246
v_and_b32 v221, 0xffff0000, v246
v_lshlrev_b32 v222, 16, v247
v_mfma_f32_16x16x32_bf16 v[72:75], v[136:139], v[120:123], v[72:75]
v_and_b32 v223, 0xffff0000, v247
v_mfma_f32_16x16x32_bf16 v[76:79], v[136:139], v[124:127], v[76:79]
v_mfma_f32_16x16x32_bf16 v[80:83], v[140:143], v[112:115], v[80:83]
v_mfma_f32_16x16x32_bf16 v[84:87], v[140:143], v[116:119], v[84:87]
v_mfma_f32_16x16x32_bf16 v[88:91], v[140:143], v[120:123], v[88:91]
v_mfma_f32_16x16x32_bf16 v[92:95], v[140:143], v[124:127], v[92:95]
s_waitcnt lgkmcnt(0)
v_bfe_u32 v6, v0, 2, 2
v_lshl_add_u32 v6, v7, 2, v6
s_lshl_b32 s57, s67, 5
v_add_u32 v6, s57, v6
v_lshlrev_b32 v6, 8, v6
v_and_b32 v5, 3, v0
v_lshl_add_u32 v6, v5, 3, v6
s_lshl_b32 s57, s66, 7
s_add_u32 s57, s57, 24576
v_add_u32 v6, s57, v6
v_and_b32 v8, 1, v7
v_lshlrev_b32 v8, 5, v8
v_lshrrev_b32 v9, 1, v7
v_lshl_add_u32 v8, v9, 4, v8
v_add3_u32 v8, v21, v8, s64
v_mfma_f32_16x16x32_bf16 v[64:67], v[176:179], v[144:147], v[64:67]
v_mfma_f32_16x16x32_bf16 v[68:71], v[176:179], v[148:151], v[68:71]
s_barrier
ds_read_b64_tr_b16 v[128:129], v228 offset:49152
ds_read_b64_tr_b16 v[130:131], v228 offset:49664
v_mfma_f32_16x16x32_bf16 v[72:75], v[176:179], v[152:155], v[72:75]
ds_read_b128 v[96:99], v224 offset:49152
ds_read_b128 v[100:103], v224 offset:51200
v_mfma_f32_16x16x32_bf16 v[76:79], v[176:179], v[156:159], v[76:79]
ds_read_b64_tr_b16 v[132:133], v229 offset:49152
ds_read_b64_tr_b16 v[134:135], v229 offset:49664
v_mfma_f32_16x16x32_bf16 v[80:83], v[180:183], v[144:147], v[80:83]
ds_read_b128 v[104:107], v224 offset:53248
ds_read_b128 v[108:111], v224 offset:55296
v_mfma_f32_16x16x32_bf16 v[84:87], v[180:183], v[148:151], v[84:87]
ds_read_b64_tr_b16 v[136:137], v228 offset:53248
ds_read_b64_tr_b16 v[138:139], v228 offset:53760
v_mfma_f32_16x16x32_bf16 v[88:91], v[180:183], v[152:155], v[88:91]
ds_read_b128 v[112:115], v225 offset:49152
ds_read_b128 v[116:119], v225 offset:51200
v_mfma_f32_16x16x32_bf16 v[92:95], v[180:183], v[156:159], v[92:95]
ds_read_b64_tr_b16 v[140:141], v229 offset:53248
ds_read_b64_tr_b16 v[142:143], v229 offset:53760
v_mfma_f32_16x16x32_bf16 v[64:67], v[184:187], v[160:163], v[64:67]
ds_read_b128 v[120:123], v225 offset:53248
ds_read_b128 v[124:127], v225 offset:55296
v_mfma_f32_16x16x32_bf16 v[68:71], v[184:187], v[164:167], v[68:71]
v_mfma_f32_16x16x32_bf16 v[72:75], v[184:187], v[168:171], v[72:75]
v_mfma_f32_16x16x32_bf16 v[76:79], v[184:187], v[172:175], v[76:79]
v_mfma_f32_16x16x32_bf16 v[80:83], v[188:191], v[160:163], v[80:83]
v_mfma_f32_16x16x32_bf16 v[84:87], v[188:191], v[164:167], v[84:87]
v_mfma_f32_16x16x32_bf16 v[88:91], v[188:191], v[168:171], v[88:91]
v_mfma_f32_16x16x32_bf16 v[92:95], v[188:191], v[172:175], v[92:95]
s_waitcnt lgkmcnt(0)
v_mfma_f32_16x16x32_bf16 v[64:67], v[128:131], v[96:99], v[64:67]
v_mfma_f32_16x16x32_bf16 v[68:71], v[128:131], v[100:103], v[68:71]
s_barrier
ds_read_b64_tr_b16 v[176:177], v230 offset:0
ds_read_b64_tr_b16 v[178:179], v230 offset:512
v_mfma_f32_16x16x32_bf16 v[72:75], v[128:131], v[104:107], v[72:75]
ds_read_b128 v[144:147], v226 offset:0
ds_read_b128 v[148:151], v226 offset:2048
v_mfma_f32_16x16x32_bf16 v[76:79], v[128:131], v[108:111], v[76:79]
ds_read_b64_tr_b16 v[180:181], v231 offset:0
ds_read_b64_tr_b16 v[182:183], v231 offset:512
v_mfma_f32_16x16x32_bf16 v[80:83], v[132:135], v[96:99], v[80:83]
ds_read_b128 v[152:155], v226 offset:4096
ds_read_b128 v[156:159], v226 offset:6144
v_mfma_f32_16x16x32_bf16 v[84:87], v[132:135], v[100:103], v[84:87]
ds_read_b64_tr_b16 v[184:185], v230 offset:4096
ds_read_b64_tr_b16 v[186:187], v230 offset:4608
v_mfma_f32_16x16x32_bf16 v[88:91], v[132:135], v[104:107], v[88:91]
ds_read_b128 v[160:163], v227 offset:0
ds_read_b128 v[164:167], v227 offset:2048
v_mfma_f32_16x16x32_bf16 v[92:95], v[132:135], v[108:111], v[92:95]
ds_read_b64_tr_b16 v[188:189], v231 offset:4096
ds_read_b64_tr_b16 v[190:191], v231 offset:4608
v_mfma_f32_16x16x32_bf16 v[64:67], v[136:139], v[112:115], v[64:67]
ds_read_b128 v[168:171], v227 offset:4096
ds_read_b128 v[172:175], v227 offset:6144
v_mfma_f32_16x16x32_bf16 v[68:71], v[136:139], v[116:119], v[68:71]
v_mfma_f32_16x16x32_bf16 v[72:75], v[136:139], v[120:123], v[72:75]
v_mfma_f32_16x16x32_bf16 v[76:79], v[136:139], v[124:127], v[76:79]
v_mfma_f32_16x16x32_bf16 v[80:83], v[140:143], v[112:115], v[80:83]
v_mfma_f32_16x16x32_bf16 v[84:87], v[140:143], v[116:119], v[84:87]
v_mfma_f32_16x16x32_bf16 v[88:91], v[140:143], v[120:123], v[88:91]
v_mfma_f32_16x16x32_bf16 v[92:95], v[140:143], v[124:127], v[92:95]
s_waitcnt lgkmcnt(0)
s_waitcnt vmcnt(0)
v_sub_f32 v34, 1.0, v32
v_sub_f32 v38, 1.0, v36
v_sub_f32 v42, 1.0, v40
v_sub_f32 v46, 1.0, v44
v_mfma_f32_16x16x32_bf16 v[64:67], v[176:179], v[144:147], v[64:67]
v_mfma_f32_16x16x32_bf16 v[68:71], v[176:179], v[148:151], v[68:71]
ds_read_b64_tr_b16 v[96:97], v6 offset:0
ds_read_b64_tr_b16 v[98:99], v6 offset:4096
v_mfma_f32_16x16x32_bf16 v[72:75], v[176:179], v[152:155], v[72:75]
ds_read_b64_tr_b16 v[100:101], v6 offset:32
ds_read_b64_tr_b16 v[102:103], v6 offset:4128
v_mfma_f32_16x16x32_bf16 v[76:79], v[176:179], v[156:159], v[76:79]
ds_read_b64_tr_b16 v[104:105], v6 offset:64
ds_read_b64_tr_b16 v[106:107], v6 offset:4160
v_mfma_f32_16x16x32_bf16 v[80:83], v[180:183], v[144:147], v[80:83]
ds_read_b64_tr_b16 v[108:109], v6 offset:96
ds_read_b64_tr_b16 v[110:111], v6 offset:4192
v_mfma_f32_16x16x32_bf16 v[84:87], v[180:183], v[148:151], v[84:87]
v_mfma_f32_16x16x32_bf16 v[88:91], v[180:183], v[152:155], v[88:91]
v_mfma_f32_16x16x32_bf16 v[92:95], v[180:183], v[156:159], v[92:95]
v_mfma_f32_16x16x32_bf16 v[64:67], v[184:187], v[160:163], v[64:67]
v_mfma_f32_16x16x32_bf16 v[68:71], v[184:187], v[164:167], v[68:71]
v_mfma_f32_16x16x32_bf16 v[72:75], v[184:187], v[168:171], v[72:75]
v_mfma_f32_16x16x32_bf16 v[76:79], v[184:187], v[172:175], v[76:79]
v_mfma_f32_16x16x32_bf16 v[80:83], v[188:191], v[160:163], v[80:83]
v_mfma_f32_16x16x32_bf16 v[84:87], v[188:191], v[164:167], v[84:87]
v_mfma_f32_16x16x32_bf16 v[88:91], v[188:191], v[168:171], v[88:91]
v_mfma_f32_16x16x32_bf16 v[92:95], v[188:191], v[172:175], v[92:95]
s_waitcnt lgkmcnt(0)
v_lshlrev_b32 v128, 16, v96
v_and_b32 v129, 0xffff0000, v96
v_lshlrev_b32 v130, 16, v97
v_and_b32 v131, 0xffff0000, v97
v_pk_mul_f32 v[128:129], v[128:129], v[192:193]
v_pk_mul_f32 v[128:129], v[128:129], v[34:35] op_sel_hi:[1,0]
v_pk_fma_f32 v[128:129], v[64:65], v[32:33], v[128:129] op_sel_hi:[1,0,1]
v_cvt_pk_bf16_f32 v112, v128, v129
v_pk_mul_f32 v[130:131], v[130:131], v[194:195]
v_pk_mul_f32 v[130:131], v[130:131], v[34:35] op_sel_hi:[1,0]
v_pk_fma_f32 v[130:131], v[66:67], v[32:33], v[130:131] op_sel_hi:[1,0,1]
v_cvt_pk_bf16_f32 v113, v130, v131
v_lshlrev_b32 v132, 16, v98
v_and_b32 v133, 0xffff0000, v98
v_lshlrev_b32 v134, 16, v99
v_and_b32 v135, 0xffff0000, v99
v_pk_mul_f32 v[132:133], v[132:133], v[196:197]
v_pk_mul_f32 v[132:133], v[132:133], v[34:35] op_sel_hi:[1,0]
v_pk_fma_f32 v[132:133], v[80:81], v[32:33], v[132:133] op_sel_hi:[1,0,1]
v_cvt_pk_bf16_f32 v114, v132, v133
v_pk_mul_f32 v[134:135], v[134:135], v[198:199]
v_pk_mul_f32 v[134:135], v[134:135], v[34:35] op_sel_hi:[1,0]
v_pk_fma_f32 v[134:135], v[82:83], v[32:33], v[134:135] op_sel_hi:[1,0,1]
v_cvt_pk_bf16_f32 v115, v134, v135
s_nop 1
v_permlane16_swap_b32 v112, v114
v_permlane16_swap_b32 v113, v115
s_mov_b32 s61, 0
buffer_store_dwordx4 v[112:115], v8, s[28:31], s61 offen
v_lshlrev_b32 v128, 16, v100
v_and_b32 v129, 0xffff0000, v100
v_lshlrev_b32 v130, 16, v101
v_and_b32 v131, 0xffff0000, v101
v_pk_mul_f32 v[128:129], v[128:129], v[200:201]
v_pk_mul_f32 v[128:129], v[128:129], v[38:39] op_sel_hi:[1,0]
v_pk_fma_f32 v[128:129], v[68:69], v[36:37], v[128:129] op_sel_hi:[1,0,1]
v_cvt_pk_bf16_f32 v116, v128, v129
v_pk_mul_f32 v[130:131], v[130:131], v[202:203]
v_pk_mul_f32 v[130:131], v[130:131], v[38:39] op_sel_hi:[1,0]
v_pk_fma_f32 v[130:131], v[70:71], v[36:37], v[130:131] op_sel_hi:[1,0,1]
v_cvt_pk_bf16_f32 v117, v130, v131
v_lshlrev_b32 v132, 16, v102
v_and_b32 v133, 0xffff0000, v102
v_lshlrev_b32 v134, 16, v103
v_and_b32 v135, 0xffff0000, v103
v_pk_mul_f32 v[132:133], v[132:133], v[204:205]
v_pk_mul_f32 v[132:133], v[132:133], v[38:39] op_sel_hi:[1,0]
v_pk_fma_f32 v[132:133], v[84:85], v[36:37], v[132:133] op_sel_hi:[1,0,1]
v_cvt_pk_bf16_f32 v118, v132, v133
v_pk_mul_f32 v[134:135], v[134:135], v[206:207]
v_pk_mul_f32 v[134:135], v[134:135], v[38:39] op_sel_hi:[1,0]
v_pk_fma_f32 v[134:135], v[86:87], v[36:37], v[134:135] op_sel_hi:[1,0,1]
v_cvt_pk_bf16_f32 v119, v134, v135
s_nop 1
v_permlane16_swap_b32 v116, v118
v_permlane16_swap_b32 v117, v119
s_mov_b32 s61, 32768
buffer_store_dwordx4 v[116:119], v8, s[28:31], s61 offen
v_lshlrev_b32 v128, 16, v104
v_and_b32 v129, 0xffff0000, v104
v_lshlrev_b32 v130, 16, v105
v_and_b32 v131, 0xffff0000, v105
v_pk_mul_f32 v[128:129], v[128:129], v[208:209]
v_pk_mul_f32 v[128:129], v[128:129], v[42:43] op_sel_hi:[1,0]
v_pk_fma_f32 v[128:129], v[72:73], v[40:41], v[128:129] op_sel_hi:[1,0,1]
v_cvt_pk_bf16_f32 v120, v128, v129
v_pk_mul_f32 v[130:131], v[130:131], v[210:211]
v_pk_mul_f32 v[130:131], v[130:131], v[42:43] op_sel_hi:[1,0]
v_pk_fma_f32 v[130:131], v[74:75], v[40:41], v[130:131] op_sel_hi:[1,0,1]
v_cvt_pk_bf16_f32 v121, v130, v131
v_lshlrev_b32 v132, 16, v106
v_and_b32 v133, 0xffff0000, v106
v_lshlrev_b32 v134, 16, v107
v_and_b32 v135, 0xffff0000, v107
v_pk_mul_f32 v[132:133], v[132:133], v[212:213]
v_pk_mul_f32 v[132:133], v[132:133], v[42:43] op_sel_hi:[1,0]
v_pk_fma_f32 v[132:133], v[88:89], v[40:41], v[132:133] op_sel_hi:[1,0,1]
v_cvt_pk_bf16_f32 v122, v132, v133
v_pk_mul_f32 v[134:135], v[134:135], v[214:215]
v_pk_mul_f32 v[134:135], v[134:135], v[42:43] op_sel_hi:[1,0]
v_pk_fma_f32 v[134:135], v[90:91], v[40:41], v[134:135] op_sel_hi:[1,0,1]
v_cvt_pk_bf16_f32 v123, v134, v135
s_nop 1
v_permlane16_swap_b32 v120, v122
v_permlane16_swap_b32 v121, v123
s_mov_b32 s61, 65536
buffer_store_dwordx4 v[120:123], v8, s[28:31], s61 offen
v_lshlrev_b32 v128, 16, v108
v_and_b32 v129, 0xffff0000, v108
v_lshlrev_b32 v130, 16, v109
v_and_b32 v131, 0xffff0000, v109
v_pk_mul_f32 v[128:129], v[128:129], v[216:217]
v_pk_mul_f32 v[128:129], v[128:129], v[46:47] op_sel_hi:[1,0]
v_pk_fma_f32 v[128:129], v[76:77], v[44:45], v[128:129] op_sel_hi:[1,0,1]
v_cvt_pk_bf16_f32 v124, v128, v129
v_pk_mul_f32 v[130:131], v[130:131], v[218:219]
v_pk_mul_f32 v[130:131], v[130:131], v[46:47] op_sel_hi:[1,0]
v_pk_fma_f32 v[130:131], v[78:79], v[44:45], v[130:131] op_sel_hi:[1,0,1]
v_cvt_pk_bf16_f32 v125, v130, v131
v_lshlrev_b32 v132, 16, v110
v_and_b32 v133, 0xffff0000, v110
v_lshlrev_b32 v134, 16, v111
v_and_b32 v135, 0xffff0000, v111
v_pk_mul_f32 v[132:133], v[132:133], v[220:221]
v_pk_mul_f32 v[132:133], v[132:133], v[46:47] op_sel_hi:[1,0]
v_pk_fma_f32 v[132:133], v[92:93], v[44:45], v[132:133] op_sel_hi:[1,0,1]
v_cvt_pk_bf16_f32 v126, v132, v133
v_pk_mul_f32 v[134:135], v[134:135], v[222:223]
v_pk_mul_f32 v[134:135], v[134:135], v[46:47] op_sel_hi:[1,0]
v_pk_fma_f32 v[134:135], v[94:95], v[44:45], v[134:135] op_sel_hi:[1,0,1]
v_cvt_pk_bf16_f32 v127, v134, v135
s_nop 1
v_permlane16_swap_b32 v124, v126
v_permlane16_swap_b32 v125, v127
s_mov_b32 s61, 98304
buffer_store_dwordx4 v[124:127], v8, s[28:31], s61 offen
s_waitcnt vmcnt(0)
s_waitcnt vmcnt(0)
Ldone:
s_endpgm
Lend:
.section .rodata,"a"
.p2align 6
.amdhsa_kernel gated_mix__linear_attn_block__ssm_conv_h3__prompt_kernel
  .amdhsa_next_free_vgpr 256
  .amdhsa_next_free_sgpr 102
  .amdhsa_accum_offset 256
  .amdhsa_group_segment_fixed_size 0
  .amdhsa_kernarg_size 104
  .amdhsa_user_sgpr_count 2
  .amdhsa_user_sgpr_kernarg_segment_ptr 1
  .amdhsa_system_sgpr_workgroup_id_x 1
  .amdhsa_float_denorm_mode_32 3
  .amdhsa_float_denorm_mode_16_64 3
.end_amdhsa_kernel
```
